```python
import torch

def _softmax(x, axis=-1):
    return torch.softmax(x, dim=axis)
def _gelu(x):
    return torch.nn.functional.gelu(x, approximate="tanh")
def _silu(x):
    return torch.nn.functional.silu(x)
def _sigmoid(x):
    return torch.sigmoid(x)
def _layernorm(x, axis=-1, eps=1e-5):
    m = x.mean(dim=axis, keepdim=True)
    v = x.var(dim=axis, keepdim=True, unbiased=False)
    return (x - m) / torch.sqrt(v + eps)
def _scatter_add(tgt, idx, src, axis=0):
    return tgt.clone().index_add_(axis, idx, src)
def _segment_sum(src, seg, n):
    out = torch.zeros((n,) + src.shape[1:], dtype=src.dtype)
    return out.index_add_(0, seg, src)
def _pad(x, pw):
    flat = tuple(v for pair in reversed(pw) for v in pair)
    return torch.nn.functional.pad(x, flat)

kernel_name = 'recurrent_scan__gqa_block_cached__swiglu_ffn__decode'

def setup_inputs():

    _w = (lambda a: (lambda t: t.to(torch.bfloat16) if t.is_floating_point() else t)(torch.as_tensor(a)))
    def _A_setup():
        B, Sq, D = 1, 1, 1024
        Hq, Hkv, Sk, Dh = 32, 4, 32768, 128
        assert Hq % Hkv == 0, (Hq, Hkv)
        return {
            "x": _w((lambda *s: torch.randn(*s, dtype=torch.bfloat16) * 0.05)(B, Sq, D)),
            "k_cache": _w((lambda *s: torch.randn(*s, dtype=torch.bfloat16) * 1.6)(B, Hkv, Sk, Dh)),
            "v_cache": _w((lambda *s: torch.randn(*s, dtype=torch.bfloat16) * 0.2)(B, Hkv, Sk, Dh)),
            "wq": _w((lambda *s: torch.randn(*s, dtype=torch.bfloat16) * 1.6)(D, Hq * Dh) * (D ** -0.5)),
            "wo": _w((lambda *s: torch.randn(*s, dtype=torch.bfloat16) * 0.2)(Hq * Dh, D) * ((Hq * Dh) ** -0.5)),
        }
    _A_in = _A_setup()

    def _B_setup():
        B, S, D, F = 1, 1, 1024, 3584
        return {
            "x": _w((lambda *s: torch.randn(*s, dtype=torch.bfloat16) * 0.05)(B, S, D)),
            "w_gate": _w((lambda *s: torch.randn(*s, dtype=torch.bfloat16) * 0.1)(D, F)),
            "w_up": _w((lambda *s: torch.randn(*s, dtype=torch.bfloat16) * 0.1)(D, F)),
            "w_down": _w((lambda *s: torch.randn(*s, dtype=torch.bfloat16) * 0.1)(F, D)),
        }
    _B_in = _B_setup()

    return {
        "A_x": _A_in["x"],
        "A_k_cache": _A_in["k_cache"],
        "A_v_cache": _A_in["v_cache"],
        "A_wq": _A_in["wq"],
        "A_wo": _A_in["wo"],
        "B_x": _B_in["x"],
        "B_w_gate": _B_in["w_gate"],
        "B_w_up": _B_in["w_up"],
        "B_w_down": _B_in["w_down"],
    }

def reference(A_x, A_k_cache, A_v_cache, A_wq, A_wo, B_x, B_w_gate, B_w_up, B_w_down):
    def _A_ref(x, k_cache, v_cache, wq, wo):
        B, Sq, D = x.shape
        Hq, Dh = 32, 128
        Hkv = k_cache.shape[1]
        rep = Hq // Hkv
        q = (lambda x, *d: x.permute(*d))((x @ wq).reshape(B, Sq, Hq, Dh), 0, 2, 1, 3)
        k = (lambda x, n, axis: torch.repeat_interleave(x, n, dim=axis))(k_cache, rep, axis=1)
        v = (lambda x, n, axis: torch.repeat_interleave(x, n, dim=axis))(v_cache, rep, axis=1)
        scores = torch.einsum("bhqd,bhkd->bhqk", q, k) * (Dh ** -0.5)
        p = _softmax(scores, axis=-1)
        o = torch.einsum("bhqk,bhkd->bhqd", p, v)
        return (lambda x, *d: x.permute(*d))(o, 0, 2, 1, 3).reshape(B, Sq, Hq * Dh) @ wo

    def _B_ref(x, w_gate, w_up, w_down):
        g = _silu(x @ w_gate)
        u = x @ w_up
        return (g * u) @ w_down

    x = A_x
    xn = _layernorm(x, axis=-1)
    s = _A_ref(xn, A_k_cache, A_v_cache, A_wq, A_wo)
    g = _silu(_B_ref(xn, B_w_gate, B_w_up, B_w_down))
    return x + s * g
```

```asm
; @launch grid=(256,1,1) block=(512,1,1) lds=157184
.amdgcn_target "amdgcn-amd-amdhsa--gfx950"
.text
.globl recurrent_scan__gqa_block_cached__swiglu_ffn__decode_kernel
.p2align 8
.type recurrent_scan__gqa_block_cached__swiglu_ffn__decode_kernel,@function
recurrent_scan__gqa_block_cached__swiglu_ffn__decode_kernel:
  s_load_dwordx16 s[4:19], s[0:1], 0
  s_load_dwordx8 s[20:27], s[0:1], 64
  v_lshrrev_b32 v2, 6, v0
  v_and_b32 v1, 63, v0
  v_readfirstlane_b32 s3, v2
  s_cmp_ge_u32 s2, 256
  s_cbranch_scc1 L_exit
  s_cmp_ge_u32 s3, 4
  s_cbranch_scc1 L_S
  s_setprio 2
  s_cmp_lg_u32 s3, 0
  s_cbranch_scc1 L_H123
  s_getpc_b64 s[56:57]
L_pc:
  s_lshr_b32 s58, s2, 3
  s_mulk_i32 s58, 1024
  v_and_b32 v2, 7, v1
  v_lshl_add_u32 v2, v2, 7, s58
  v_min_u32 v2, L_exit-L_pc, v2
  v_mov_b32 v3, s57
  v_add_co_u32 v2, vcc, s56, v2
  s_nop 1
  v_addc_co_u32 v3, vcc, 0, v3, vcc
  global_load_dword v255, v[2:3], off
  v_lshlrev_b32 v7, 5, v1
  v_mov_b32 v8, 245760
  s_waitcnt lgkmcnt(0)
  global_load_dwordx4 v[40:43], v7, s[4:5]
  global_load_dwordx4 v[44:47], v7, s[4:5] offset:16
  global_load_dword v14, v8, s[26:27] sc1
  s_branch L_H0
L_S:
  s_sub_u32 s63, s3, 4
  s_bfe_u32 s53, s2, 0x20003
  s_add_u32 s54, s2, s53
  s_and_b32 s54, s54, 7
  s_lshl3_add_u32 s54, s53, s54
  s_lshr_b32 s55, s2, 5
  s_lshl2_add_u32 s53, s55, s63
  s_lshl_b32 s52, s53, 10
  s_add_u32 s52, s52, s54
  s_lshl_b32 s52, s52, 8
  v_lshrrev_b32 v2, 4, v1
  v_and_b32 v3, 15, v1
  v_lshlrev_b32 v4, 4, v3
  v_lshl_add_u32 v6, v2, 16, v4
  s_movk_i32 s57, 0x2000
  s_lshl_b32 s34, s57, 10
  s_mov_b32 s35, 0x20000
  s_waitcnt lgkmcnt(0)
  s_mov_b64 s[32:33], s[10:11]
  buffer_load_dwordx4 v[128:131], v6, s[32:35], s52 offen nt
  s_add_u32 s52, s52, s57
  buffer_load_dwordx4 v[132:135], v6, s[32:35], s52 offen nt
  s_add_u32 s52, s52, s57
  buffer_load_dwordx4 v[136:139], v6, s[32:35], s52 offen nt
  s_add_u32 s52, s52, s57
  buffer_load_dwordx4 v[140:143], v6, s[32:35], s52 offen nt
  s_add_u32 s52, s52, s57
  buffer_load_dwordx4 v[144:147], v6, s[32:35], s52 offen nt
  s_add_u32 s52, s52, s57
  buffer_load_dwordx4 v[148:151], v6, s[32:35], s52 offen nt
  s_add_u32 s52, s52, s57
  s_mov_b32 s60, 0x05040100
  s_mov_b32 s61, 0x07060302
  s_mov_b32 s62, 1000000
  s_mov_b32 s28, s26
  s_mov_b32 s29, s27
  s_mov_b32 s30, 1605632
  s_mov_b32 s31, 0x20000
  s_lshr_b32 s51, s63, 1
  s_cmp_ge_u32 s2, 192
  s_cbranch_scc1 L_gjsa
  s_lshr_b32 s59, s2, 6
  s_add_u32 s59, s59, s51
  s_cmp_eq_u32 s59, 3
  s_cselect_b32 s59, 0, s59
  s_add_u32 s58, s2, s59
  s_and_b32 s58, s58, 7
  s_lshl3_add_u32 s58, s59, s58
  s_mov_b32 s56, s51
  s_bfe_u32 s55, s2, 0x30003
  s_branch L_gjsb
L_gjsa:
  s_bfe_u32 s58, s2, 0x20001
  s_add_u32 s58, s58, 24
  s_and_b32 s56, s2, 1
  s_bfe_u32 s55, s2, 0x20003
  s_lshl1_add_u32 s55, s55, s51
L_gjsb:
  s_cmp_eq_u32 s56, 1
  s_cselect_b64 s[36:37], s[18:19], s[16:17]
  s_mov_b32 s38, 7340032
  s_mov_b32 s39, 0x20000
  s_lshl_b32 s58, s58, 8
  s_and_b32 s59, s63, 1
  s_lshl1_add_u32 s59, s55, s59
  s_mul_i32 s50, s59, 458752
  s_add_u32 s50, s50, s58
  v_mul_u32_u24 v7, 57344, v2
  v_add_u32 v7, v7, v4
  s_lshl_b32 s53, s53, 6
  s_add_u32 s53, s53, 147968
  v_lshl_add_u32 v12, v2, 4, s53
  s_lshl_b32 s59, s59, 7
  s_add_u32 s59, s59, 147968
  v_lshl_add_u32 v13, v2, 4, s59
  s_lshl_b32 s59, s63, 9
  s_add_u32 s59, s59, 153088
  v_lshlrev_b32 v14, 5, v3
  v_lshl_add_u32 v14, v2, 4, v14
  v_add_u32 v14, s59, v14
  s_waitcnt vmcnt(5)
  buffer_load_dwordx4 v[152:155], v6, s[32:35], s52 offen nt
  s_add_u32 s52, s52, s57
  s_waitcnt vmcnt(5)
  buffer_load_dwordx4 v[156:159], v6, s[32:35], s52 offen nt
  s_bfe_u32 s88, s2, 0x20003
  s_lshl_b32 s88, s88, 23
  s_bitcmp1_b32 s63, 0
  s_cselect_b32 s56, 8192, 0
  s_xor_b32 s88, s88, s56
  s_bitcmp1_b32 s63, 1
  s_cselect_b32 s56, 16384, 0
  s_xor_b32 s88, s88, s56
  s_bitcmp1_b32 s2, 0
  s_cselect_b32 s56, 1024, 0
  s_xor_b32 s88, s88, s56
  s_bitcmp1_b32 s2, 1
  s_cselect_b32 s56, 525312, 0
  s_xor_b32 s88, s88, s56
  s_bitcmp1_b32 s2, 2
  s_cselect_b32 s56, 73728, 0
  s_xor_b32 s88, s88, s56
  s_bitcmp1_b32 s2, 3
  s_cselect_b32 s56, 3407872, 0
  s_xor_b32 s88, s88, s56
  s_bitcmp1_b32 s2, 4
  s_cselect_b32 s56, 5275648, 0
  s_xor_b32 s88, s88, s56
  s_bitcmp1_b32 s2, 5
  s_cselect_b32 s56, 262144, 0
  s_xor_b32 s88, s88, s56
  s_bitcmp1_b32 s2, 6
  s_cselect_b32 s56, 32768, 0
  s_xor_b32 s88, s88, s56
  s_bitcmp1_b32 s2, 7
  s_cselect_b32 s56, 2195456, 0
  s_xor_b32 s88, s88, s56
  s_lshl_b32 s55, s63, 15
  v_and_b32 v5, 1, v2
  v_lshl_add_u32 v9, v5, 8, v4
  v_lshrrev_b32 v5, 1, v2
  v_lshl_add_u32 v9, v5, 9, v9
  v_lshlrev_b32 v5, 6, v2
  v_xor_b32 v16, v5, v9
  v_xor_b32 v17, 16, v16
  v_xor_b32 v18, 32, v16
  v_xor_b32 v19, 48, v16
  s_mov_b32 s40, s6
  s_mov_b32 s41, s7
  s_mov_b32 s42, 33554432
  s_mov_b32 s43, 0x20000
  s_mov_b32 s44, s8
  s_mov_b32 s45, s9
  s_mov_b32 s46, 33554432
  s_mov_b32 s47, 0x20000
  s_cmp_ge_u32 s2, 224
  s_cbranch_scc1 L_light
  s_waitcnt vmcnt(5)
  buffer_load_dwordx4 v[160:163], v7, s[36:39], s50 offen nt
  s_add_u32 s50, s50, 7168
  s_waitcnt vmcnt(5)
  buffer_load_dwordx4 v[164:167], v7, s[36:39], s50 offen nt
  s_add_u32 s50, s50, 7168
  s_barrier
  s_waitcnt vmcnt(5)
  buffer_load_dwordx4 v[168:171], v7, s[36:39], s50 offen nt
  s_add_u32 s50, s50, 7168
  s_waitcnt vmcnt(5)
  buffer_load_dwordx4 v[172:175], v7, s[36:39], s50 offen nt
  s_add_u32 s50, s50, 7168
  v_mov_b32 v20, 152960
  ds_write_b32 v20, v20 offset:56
  s_waitcnt vmcnt(5)
  buffer_load_dwordx4 v[176:179], v7, s[36:39], s50 offen nt
  s_add_u32 s50, s50, 7168
  s_waitcnt vmcnt(5)
  buffer_load_dwordx4 v[180:183], v7, s[36:39], s50 offen nt
  s_add_u32 s50, s50, 7168
  s_waitcnt vmcnt(5)
  buffer_load_dwordx4 v[184:187], v7, s[36:39], s50 offen nt
  s_add_u32 s50, s50, 7168
  s_waitcnt vmcnt(5)
  buffer_load_dwordx4 v[188:191], v7, s[36:39], s50 offen nt
  s_add_u32 s50, s50, 179200
  s_waitcnt vmcnt(5)
  buffer_load_dwordx4 v[192:195], v7, s[36:39], s50 offen nt
  s_add_u32 s50, s50, 7168
  s_waitcnt vmcnt(5)
  buffer_load_dwordx4 v[196:199], v7, s[36:39], s50 offen nt
  s_add_u32 s50, s50, 7168
  v_mov_b32 v20, 152960
L_xw1:
  ds_read_b32 v21, v20 offset:0
  s_waitcnt lgkmcnt(0)
  v_cmp_eq_u32 vcc, -1, v21
  s_nop 0
  s_cbranch_vccz L_xw1_ok
  s_sleep 1
  s_sub_u32 s62, s62, 1
  s_cmp_gt_i32 s62, 0
  s_cbranch_scc1 L_xw1
L_xw1_ok:
  ds_read_b128 v[32:35], v12
  ds_read_b128 v[36:39], v13
  ds_read_b128 v[40:43], v13 offset:64
  s_waitcnt lgkmcnt(0)
  v_perm_b32 v96, v132, v128, s60
  v_perm_b32 v100, v132, v128, s61
  v_perm_b32 v104, v133, v129, s60
  v_perm_b32 v108, v133, v129, s61
  v_perm_b32 v112, v134, v130, s60
  v_perm_b32 v116, v134, v130, s61
  v_perm_b32 v120, v135, v131, s60
  v_perm_b32 v124, v135, v131, s61
  v_perm_b32 v97, v140, v136, s60
  v_perm_b32 v101, v140, v136, s61
  v_perm_b32 v105, v141, v137, s60
  v_perm_b32 v109, v141, v137, s61
  v_perm_b32 v113, v142, v138, s60
  v_perm_b32 v117, v142, v138, s61
  v_perm_b32 v121, v143, v139, s60
  v_perm_b32 v125, v143, v139, s61
  s_waitcnt vmcnt(5)
  buffer_load_dwordx4 v[200:203], v7, s[36:39], s50 offen nt
  s_add_u32 s50, s50, 7168
  v_perm_b32 v98, v148, v144, s60
  v_perm_b32 v102, v148, v144, s61
  v_perm_b32 v106, v149, v145, s60
  v_perm_b32 v110, v149, v145, s61
  v_perm_b32 v114, v150, v146, s60
  v_perm_b32 v118, v150, v146, s61
  v_perm_b32 v122, v151, v147, s60
  v_perm_b32 v126, v151, v147, s61
  v_perm_b32 v99, v156, v152, s60
  v_perm_b32 v103, v156, v152, s61
  v_perm_b32 v107, v157, v153, s60
  v_perm_b32 v111, v157, v153, s61
  v_perm_b32 v115, v158, v154, s60
  v_perm_b32 v119, v158, v154, s61
  v_perm_b32 v123, v159, v155, s60
  v_perm_b32 v127, v159, v155, s61
  v_mfma_f32_16x16x32_bf16 v[64:67], v[32:35], v[96:99], 0
  v_mfma_f32_16x16x32_bf16 v[68:71], v[32:35], v[100:103], 0
  v_mfma_f32_16x16x32_bf16 v[72:75], v[32:35], v[104:107], 0
  v_mfma_f32_16x16x32_bf16 v[76:79], v[32:35], v[108:111], 0
  v_mfma_f32_16x16x32_bf16 v[80:83], v[32:35], v[112:115], 0
  v_mfma_f32_16x16x32_bf16 v[84:87], v[32:35], v[116:119], 0
  v_mfma_f32_16x16x32_bf16 v[88:91], v[32:35], v[120:123], 0
  v_mfma_f32_16x16x32_bf16 v[92:95], v[32:35], v[124:127], 0
  s_waitcnt vmcnt(5)
  buffer_load_dwordx4 v[204:207], v7, s[36:39], s50 offen nt
  s_add_u32 s50, s50, 7168
  v_mov_b32 v20, v64
  v_mov_b32 v21, v68
  v_mov_b32 v22, v72
  v_mov_b32 v23, v76
  v_mov_b32_dpp v20, v80 quad_perm:[0,1,2,3] row_mask:0x2 bank_mask:0xf
  v_mov_b32_dpp v21, v84 quad_perm:[0,1,2,3] row_mask:0x2 bank_mask:0xf
  v_mov_b32_dpp v22, v88 quad_perm:[0,1,2,3] row_mask:0x2 bank_mask:0xf
  v_mov_b32_dpp v23, v92 quad_perm:[0,1,2,3] row_mask:0x2 bank_mask:0xf
  s_mov_b32 exec_hi, 0
  ds_write_b128 v14, v[20:23] offset:0
  s_mov_b64 exec, -1
  s_waitcnt vmcnt(5)
  buffer_load_dwordx4 v[208:211], v7, s[36:39], s50 offen nt
  s_add_u32 s50, s50, 7168
  s_waitcnt vmcnt(5)
  buffer_load_dwordx4 v[212:215], v7, s[36:39], s50 offen nt
  s_add_u32 s50, s50, 7168
  v_perm_b32 v96, v164, v160, s60
  v_perm_b32 v100, v164, v160, s61
  v_perm_b32 v104, v165, v161, s60
  v_perm_b32 v108, v165, v161, s61
  v_perm_b32 v112, v166, v162, s60
  v_perm_b32 v116, v166, v162, s61
  v_perm_b32 v120, v167, v163, s60
  v_perm_b32 v124, v167, v163, s61
  v_perm_b32 v97, v172, v168, s60
  v_perm_b32 v101, v172, v168, s61
  v_perm_b32 v105, v173, v169, s60
  v_perm_b32 v109, v173, v169, s61
  v_perm_b32 v113, v174, v170, s60
  v_perm_b32 v117, v174, v170, s61
  v_perm_b32 v121, v175, v171, s60
  v_perm_b32 v125, v175, v171, s61
  v_perm_b32 v98, v180, v176, s60
  v_perm_b32 v102, v180, v176, s61
  v_perm_b32 v106, v181, v177, s60
  v_perm_b32 v110, v181, v177, s61
  v_perm_b32 v114, v182, v178, s60
  v_perm_b32 v118, v182, v178, s61
  v_perm_b32 v122, v183, v179, s60
  v_perm_b32 v126, v183, v179, s61
  s_waitcnt vmcnt(5)
  buffer_load_dwordx4 v[216:219], v7, s[36:39], s50 offen nt
  s_add_u32 s50, s50, 7168
  v_perm_b32 v99, v188, v184, s60
  v_perm_b32 v103, v188, v184, s61
  v_perm_b32 v107, v189, v185, s60
  v_perm_b32 v111, v189, v185, s61
  v_perm_b32 v115, v190, v186, s60
  v_perm_b32 v119, v190, v186, s61
  v_perm_b32 v123, v191, v187, s60
  v_perm_b32 v127, v191, v187, s61
  v_mfma_f32_16x16x32_bf16 v[64:67], v[36:39], v[96:99], 0
  v_mfma_f32_16x16x32_bf16 v[68:71], v[36:39], v[100:103], 0
  v_mfma_f32_16x16x32_bf16 v[72:75], v[36:39], v[104:107], 0
  v_mfma_f32_16x16x32_bf16 v[76:79], v[36:39], v[108:111], 0
  v_mfma_f32_16x16x32_bf16 v[80:83], v[36:39], v[112:115], 0
  v_mfma_f32_16x16x32_bf16 v[84:87], v[36:39], v[116:119], 0
  v_mfma_f32_16x16x32_bf16 v[88:91], v[36:39], v[120:123], 0
  v_mfma_f32_16x16x32_bf16 v[92:95], v[36:39], v[124:127], 0
  s_waitcnt vmcnt(5)
  buffer_load_dwordx4 v[220:223], v7, s[36:39], s50 offen nt
  s_add_u32 m0, s55, 0
  s_xor_b32 s56, s88, 0
  s_waitcnt vmcnt(5)
  buffer_load_dwordx4 v16, s[40:43], s56 offen offset:0 nt lds
  s_add_u32 m0, s55, 1024
  s_xor_b32 s56, s88, 4096
  s_waitcnt vmcnt(5)
  buffer_load_dwordx4 v17, s[40:43], s56 offen offset:0 nt lds
  s_add_u32 m0, s55, 2048
  s_xor_b32 s56, s88, 2048
  s_waitcnt vmcnt(5)
  buffer_load_dwordx4 v18, s[40:43], s56 offen offset:0 nt lds
  s_add_u32 m0, s55, 3072
  s_xor_b32 s56, s88, 6144
  s_waitcnt vmcnt(5)
  buffer_load_dwordx4 v19, s[40:43], s56 offen offset:0 nt lds
  s_add_u32 m0, s55, 4096
  s_xor_b32 s56, s88, 2260992
  s_waitcnt vmcnt(5)
  buffer_load_dwordx4 v16, s[40:43], s56 offen offset:0 nt lds
  s_add_u32 m0, s55, 5120
  s_xor_b32 s56, s88, 2265088
  s_waitcnt vmcnt(5)
  buffer_load_dwordx4 v17, s[40:43], s56 offen offset:0 nt lds
  v_perm_b32 v96, v196, v192, s60
  v_perm_b32 v100, v196, v192, s61
  v_perm_b32 v104, v197, v193, s60
  v_perm_b32 v108, v197, v193, s61
  v_perm_b32 v112, v198, v194, s60
  v_perm_b32 v116, v198, v194, s61
  v_perm_b32 v120, v199, v195, s60
  v_perm_b32 v124, v199, v195, s61
  v_perm_b32 v97, v204, v200, s60
  v_perm_b32 v101, v204, v200, s61
  v_perm_b32 v105, v205, v201, s60
  v_perm_b32 v109, v205, v201, s61
  v_perm_b32 v113, v206, v202, s60
  v_perm_b32 v117, v206, v202, s61
  v_perm_b32 v121, v207, v203, s60
  v_perm_b32 v125, v207, v203, s61
  v_perm_b32 v98, v212, v208, s60
  v_perm_b32 v102, v212, v208, s61
  v_perm_b32 v106, v213, v209, s60
  v_perm_b32 v110, v213, v209, s61
  v_perm_b32 v114, v214, v210, s60
  v_perm_b32 v118, v214, v210, s61
  v_perm_b32 v122, v215, v211, s60
  v_perm_b32 v126, v215, v211, s61
  s_add_u32 m0, s55, 6144
  s_xor_b32 s56, s88, 2263040
  s_waitcnt vmcnt(5)
  buffer_load_dwordx4 v18, s[40:43], s56 offen offset:0 nt lds
  v_perm_b32 v99, v220, v216, s60
  v_perm_b32 v103, v220, v216, s61
  v_perm_b32 v107, v221, v217, s60
  v_perm_b32 v111, v221, v217, s61
  v_perm_b32 v115, v222, v218, s60
  v_perm_b32 v119, v222, v218, s61
  v_perm_b32 v123, v223, v219, s60
  v_perm_b32 v127, v223, v219, s61
  v_mfma_f32_16x16x32_bf16 v[64:67], v[40:43], v[96:99], v[64:67]
  v_mfma_f32_16x16x32_bf16 v[68:71], v[40:43], v[100:103], v[68:71]
  v_mfma_f32_16x16x32_bf16 v[72:75], v[40:43], v[104:107], v[72:75]
  v_mfma_f32_16x16x32_bf16 v[76:79], v[40:43], v[108:111], v[76:79]
  v_mfma_f32_16x16x32_bf16 v[80:83], v[40:43], v[112:115], v[80:83]
  v_mfma_f32_16x16x32_bf16 v[84:87], v[40:43], v[116:119], v[84:87]
  v_mfma_f32_16x16x32_bf16 v[88:91], v[40:43], v[120:123], v[88:91]
  v_mfma_f32_16x16x32_bf16 v[92:95], v[40:43], v[124:127], v[92:95]
  s_nop 0
  v_mov_b32 v20, v64
  v_mov_b32 v21, v68
  v_mov_b32 v22, v72
  v_mov_b32 v23, v76
  v_mov_b32_dpp v20, v80 quad_perm:[0,1,2,3] row_mask:0x2 bank_mask:0xf
  v_mov_b32_dpp v21, v84 quad_perm:[0,1,2,3] row_mask:0x2 bank_mask:0xf
  v_mov_b32_dpp v22, v88 quad_perm:[0,1,2,3] row_mask:0x2 bank_mask:0xf
  v_mov_b32_dpp v23, v92 quad_perm:[0,1,2,3] row_mask:0x2 bank_mask:0xf
  s_mov_b32 exec_hi, 0
  ds_write_b128 v14, v[20:23] offset:2048
  s_mov_b64 exec, -1
  s_add_u32 m0, s55, 7168
  s_xor_b32 s56, s88, 2267136
  s_waitcnt vmcnt(5)
  buffer_load_dwordx4 v19, s[40:43], s56 offen offset:0 nt lds
  s_add_u32 m0, s55, 8192
  s_xor_b32 s56, s88, 1056768
  s_waitcnt vmcnt(5)
  buffer_load_dwordx4 v16, s[40:43], s56 offen offset:0 nt lds
  s_add_u32 m0, s55, 9216
  s_xor_b32 s56, s88, 1060864
  s_waitcnt vmcnt(5)
  buffer_load_dwordx4 v17, s[40:43], s56 offen offset:0 nt lds
  s_add_u32 m0, s55, 10240
  s_xor_b32 s56, s88, 1058816
  s_waitcnt vmcnt(5)
  buffer_load_dwordx4 v18, s[40:43], s56 offen offset:0 nt lds
  s_add_u32 m0, s55, 11264
  s_xor_b32 s56, s88, 1062912
  s_waitcnt vmcnt(5)
  buffer_load_dwordx4 v19, s[40:43], s56 offen offset:0 nt lds
  s_add_u32 m0, s55, 12288
  s_xor_b32 s56, s88, 3317760
  s_waitcnt vmcnt(5)
  buffer_load_dwordx4 v16, s[40:43], s56 offen offset:0 nt lds
  s_add_u32 m0, s55, 13312
  s_xor_b32 s56, s88, 3321856
  s_waitcnt vmcnt(5)
  buffer_load_dwordx4 v17, s[40:43], s56 offen offset:0 nt lds
  s_add_u32 m0, s55, 14336
  s_xor_b32 s56, s88, 3319808
  s_waitcnt vmcnt(5)
  buffer_load_dwordx4 v18, s[40:43], s56 offen offset:0 nt lds
  s_add_u32 m0, s55, 15360
  s_xor_b32 s56, s88, 3323904
  s_waitcnt vmcnt(5)
  buffer_load_dwordx4 v19, s[40:43], s56 offen offset:0 nt lds
  v_and_b32 v14, 3, v3
  v_lshlrev_b32 v14, 2, v14
  v_lshrrev_b32 v15, 2, v3
  v_add_u32 v14, v14, v15
  v_lshlrev_b32 v14, 8, v14
  v_add_u32 v14, s55, v14
  v_xor_b32 v15, v2, v3
  v_xor_b32 v10, 0, v15
  v_lshl_add_u32 v10, v10, 4, v14
  v_xor_b32 v11, 4, v15
  v_lshl_add_u32 v11, v11, 4, v14
  v_xor_b32 v12, 8, v15
  v_lshl_add_u32 v12, v12, 4, v14
  v_xor_b32 v13, 12, v15
  v_lshl_add_u32 v13, v13, 4, v14
  s_add_u32 m0, s55, 16384
  s_xor_b32 s56, s88, 4194304
  s_waitcnt vmcnt(5)
  buffer_load_dwordx4 v16, s[40:43], s56 offen offset:0 nt lds
  s_add_u32 m0, s55, 17408
  s_xor_b32 s56, s88, 4198400
  s_waitcnt vmcnt(5)
  buffer_load_dwordx4 v17, s[40:43], s56 offen offset:0 nt lds
  s_add_u32 m0, s55, 18432
  s_xor_b32 s56, s88, 4196352
  s_waitcnt vmcnt(5)
  buffer_load_dwordx4 v18, s[40:43], s56 offen offset:0 nt lds
  s_add_u32 m0, s55, 19456
  s_xor_b32 s56, s88, 4200448
  s_waitcnt vmcnt(5)
  buffer_load_dwordx4 v19, s[40:43], s56 offen offset:0 nt lds
  s_add_u32 m0, s55, 20480
  s_xor_b32 s56, s88, 6455296
  s_waitcnt vmcnt(5)
  buffer_load_dwordx4 v16, s[40:43], s56 offen offset:0 nt lds
  s_add_u32 m0, s55, 21504
  s_xor_b32 s56, s88, 6459392
  s_waitcnt vmcnt(5)
  buffer_load_dwordx4 v17, s[40:43], s56 offen offset:0 nt lds
  s_add_u32 m0, s55, 22528
  s_xor_b32 s56, s88, 6457344
  s_waitcnt vmcnt(5)
  buffer_load_dwordx4 v18, s[40:43], s56 offen offset:0 nt lds
  s_add_u32 m0, s55, 23552
  s_xor_b32 s56, s88, 6461440
  s_waitcnt vmcnt(5)
  buffer_load_dwordx4 v19, s[40:43], s56 offen offset:0 nt lds
  s_add_u32 m0, s55, 24576
  s_xor_b32 s56, s88, 5251072
  s_waitcnt vmcnt(5)
  buffer_load_dwordx4 v16, s[40:43], s56 offen offset:0 nt lds
  s_add_u32 m0, s55, 25600
  s_xor_b32 s56, s88, 5255168
  s_waitcnt vmcnt(5)
  buffer_load_dwordx4 v17, s[40:43], s56 offen offset:0 nt lds
  s_add_u32 m0, s55, 26624
  s_xor_b32 s56, s88, 5253120
  s_waitcnt vmcnt(5)
  buffer_load_dwordx4 v18, s[40:43], s56 offen offset:0 nt lds
  v_mov_b32 v20, 152960
  ds_write_b32 v20, v20 offset:4
  s_add_u32 m0, s55, 27648
  s_xor_b32 s56, s88, 5257216
  s_waitcnt vmcnt(5)
  buffer_load_dwordx4 v19, s[40:43], s56 offen offset:0 nt lds
  s_add_u32 m0, s55, 28672
  s_xor_b32 s56, s88, 7512064
  s_waitcnt vmcnt(5)
  buffer_load_dwordx4 v16, s[40:43], s56 offen offset:0 nt lds
  s_add_u32 m0, s55, 29696
  s_xor_b32 s56, s88, 7516160
  s_waitcnt vmcnt(5)
  buffer_load_dwordx4 v17, s[40:43], s56 offen offset:0 nt lds
  s_add_u32 m0, s55, 30720
  s_xor_b32 s56, s88, 7514112
  s_waitcnt vmcnt(5)
  buffer_load_dwordx4 v18, s[40:43], s56 offen offset:0 nt lds
  s_add_u32 m0, s55, 31744
  s_xor_b32 s56, s88, 7518208
  s_waitcnt vmcnt(5)
  buffer_load_dwordx4 v19, s[40:43], s56 offen offset:0 nt lds
  v_and_b32 v8, 7, v1
  v_mul_u32_u24 v14, 272, v8
  v_lshl_add_u32 v14, v2, 4, v14
  v_add_u32 v14, 150016, v14
  v_cmp_gt_u32 vcc, 8, v3
  s_nop 1
  v_cndmask_b32 v15, 0, -1, vcc
  v_not_b32 v16, v15
  v_lshlrev_b32 v17, 3, v8
  v_add_u32 v17, 152192, v17
  s_xor_b32 s56, s88, 0
  s_waitcnt vmcnt(5)
  buffer_load_dwordx4 v[128:131], v9, s[44:47], s56 offen offset:0 nt
  s_xor_b32 s56, s88, 4096
  s_waitcnt vmcnt(5)
  buffer_load_dwordx4 v[132:135], v9, s[44:47], s56 offen offset:0 nt
  s_xor_b32 s56, s88, 2048
  s_waitcnt vmcnt(5)
  buffer_load_dwordx4 v[136:139], v9, s[44:47], s56 offen offset:0 nt
  s_xor_b32 s56, s88, 6144
  s_waitcnt vmcnt(5)
  buffer_load_dwordx4 v[140:143], v9, s[44:47], s56 offen offset:0 nt
  s_xor_b32 s56, s88, 2260992
  s_waitcnt vmcnt(5)
  buffer_load_dwordx4 v[144:147], v9, s[44:47], s56 offen offset:0 nt
  s_xor_b32 s56, s88, 2265088
  s_waitcnt vmcnt(5)
  buffer_load_dwordx4 v[148:151], v9, s[44:47], s56 offen offset:0 nt
  s_xor_b32 s56, s88, 2263040
  s_waitcnt vmcnt(5)
  buffer_load_dwordx4 v[152:155], v9, s[44:47], s56 offen offset:0 nt
  s_xor_b32 s56, s88, 2267136
  s_waitcnt vmcnt(5)
  buffer_load_dwordx4 v[156:159], v9, s[44:47], s56 offen offset:0 nt
  s_waitcnt vmcnt(8)
L_qw:
  ds_read_b128 v[64:67], v14 offset:0
  ds_read_b128 v[68:71], v14 offset:64
  ds_read_b128 v[72:75], v14 offset:128
  ds_read_b128 v[76:79], v14 offset:192
  s_waitcnt lgkmcnt(0)
  v_max3_u32 v18, v64, v65, v66
  v_max3_u32 v18, v18, v67, v68
  v_max3_u32 v18, v18, v69, v70
  v_max3_u32 v18, v18, v71, v72
  v_max3_u32 v18, v18, v73, v74
  v_max3_u32 v18, v18, v75, v76
  v_max3_u32 v18, v18, v77, v78
  v_max_u32 v18, v18, v79
  v_cmp_eq_u32 vcc, -1, v18
  s_nop 0
  s_cbranch_vccz L_qw_ok
  s_sleep 1
  s_sub_u32 s62, s62, 1
  s_cmp_gt_i32 s62, 0
  s_cbranch_scc1 L_qw
L_qw_ok:
  ds_read_b128 v[96:99], v10 offset:0
  ds_read_b128 v[100:103], v11 offset:0
  ds_read_b128 v[104:107], v12 offset:0
  ds_read_b128 v[108:111], v13 offset:0
  ds_read_b128 v[112:115], v10 offset:8192
  ds_read_b128 v[116:119], v11 offset:8192
  ds_read_b128 v[120:123], v12 offset:8192
  ds_read_b128 v[124:127], v13 offset:8192
  s_xor_b32 s56, s88, 1056768
  s_waitcnt vmcnt(5)
  buffer_load_dwordx4 v[160:163], v9, s[44:47], s56 offen offset:0 nt
  v_and_b32 v80, v16, v64
  v_and_b32 v64, v15, v64
  v_and_b32 v81, v16, v65
  v_and_b32 v65, v15, v65
  v_and_b32 v82, v16, v66
  v_and_b32 v66, v15, v66
  v_and_b32 v83, v16, v67
  v_and_b32 v67, v15, v67
  v_and_b32 v84, v16, v68
  v_and_b32 v68, v15, v68
  v_and_b32 v85, v16, v69
  v_and_b32 v69, v15, v69
  v_and_b32 v86, v16, v70
  v_and_b32 v70, v15, v70
  v_and_b32 v87, v16, v71
  v_and_b32 v71, v15, v71
  v_and_b32 v88, v16, v72
  v_and_b32 v72, v15, v72
  v_and_b32 v89, v16, v73
  v_and_b32 v73, v15, v73
  v_and_b32 v90, v16, v74
  v_and_b32 v74, v15, v74
  v_and_b32 v91, v16, v75
  v_and_b32 v75, v15, v75
  v_and_b32 v92, v16, v76
  v_and_b32 v76, v15, v76
  v_and_b32 v93, v16, v77
  v_and_b32 v77, v15, v77
  v_and_b32 v94, v16, v78
  v_and_b32 v78, v15, v78
  v_and_b32 v95, v16, v79
  v_and_b32 v79, v15, v79
  s_waitcnt lgkmcnt(4)
  v_mfma_f32_16x16x32_bf16 v[32:35], v[96:99], v[64:67], 0
  v_mfma_f32_16x16x32_bf16 v[32:35], v[100:103], v[68:71], v[32:35]
  v_mfma_f32_16x16x32_bf16 v[32:35], v[104:107], v[72:75], v[32:35]
  v_mfma_f32_16x16x32_bf16 v[32:35], v[108:111], v[76:79], v[32:35]
  ds_read_b128 v[96:99], v10 offset:4096
  ds_read_b128 v[100:103], v11 offset:4096
  ds_read_b128 v[104:107], v12 offset:4096
  ds_read_b128 v[108:111], v13 offset:4096
  s_waitcnt lgkmcnt(4)
  v_mfma_f32_16x16x32_bf16 v[32:35], v[112:115], v[80:83], v[32:35]
  v_mfma_f32_16x16x32_bf16 v[32:35], v[116:119], v[84:87], v[32:35]
  v_mfma_f32_16x16x32_bf16 v[32:35], v[120:123], v[88:91], v[32:35]
  v_mfma_f32_16x16x32_bf16 v[32:35], v[124:127], v[92:95], v[32:35]
  ds_read_b128 v[112:115], v10 offset:12288
  ds_read_b128 v[116:119], v11 offset:12288
  ds_read_b128 v[120:123], v12 offset:12288
  ds_read_b128 v[124:127], v13 offset:12288
  s_xor_b32 s56, s88, 1060864
  s_waitcnt vmcnt(5)
  buffer_load_dwordx4 v[164:167], v9, s[44:47], s56 offen offset:0 nt
  s_waitcnt lgkmcnt(4)
  v_mfma_f32_16x16x32_bf16 v[36:39], v[96:99], v[64:67], 0
  v_mfma_f32_16x16x32_bf16 v[36:39], v[100:103], v[68:71], v[36:39]
  v_mfma_f32_16x16x32_bf16 v[36:39], v[104:107], v[72:75], v[36:39]
  v_mfma_f32_16x16x32_bf16 v[36:39], v[108:111], v[76:79], v[36:39]
  ds_read_b128 v[96:99], v10 offset:16384
  ds_read_b128 v[100:103], v11 offset:16384
  ds_read_b128 v[104:107], v12 offset:16384
  ds_read_b128 v[108:111], v13 offset:16384
  s_waitcnt lgkmcnt(4)
  v_mfma_f32_16x16x32_bf16 v[36:39], v[112:115], v[80:83], v[36:39]
  v_mfma_f32_16x16x32_bf16 v[36:39], v[116:119], v[84:87], v[36:39]
  v_mfma_f32_16x16x32_bf16 v[36:39], v[120:123], v[88:91], v[36:39]
  v_mfma_f32_16x16x32_bf16 v[36:39], v[124:127], v[92:95], v[36:39]
  ds_read_b128 v[112:115], v10 offset:24576
  ds_read_b128 v[116:119], v11 offset:24576
  ds_read_b128 v[120:123], v12 offset:24576
  ds_read_b128 v[124:127], v13 offset:24576
  s_waitcnt lgkmcnt(4)
  v_mfma_f32_16x16x32_bf16 v[40:43], v[96:99], v[64:67], 0
  v_mfma_f32_16x16x32_bf16 v[40:43], v[100:103], v[68:71], v[40:43]
  v_mfma_f32_16x16x32_bf16 v[40:43], v[104:107], v[72:75], v[40:43]
  v_mfma_f32_16x16x32_bf16 v[40:43], v[108:111], v[76:79], v[40:43]
  ds_read_b128 v[96:99], v10 offset:20480
  ds_read_b128 v[100:103], v11 offset:20480
  ds_read_b128 v[104:107], v12 offset:20480
  ds_read_b128 v[108:111], v13 offset:20480
  s_xor_b32 s56, s88, 1058816
  s_waitcnt vmcnt(5)
  buffer_load_dwordx4 v[168:171], v9, s[44:47], s56 offen offset:0 nt
  s_waitcnt lgkmcnt(4)
  v_mfma_f32_16x16x32_bf16 v[40:43], v[112:115], v[80:83], v[40:43]
  v_mfma_f32_16x16x32_bf16 v[40:43], v[116:119], v[84:87], v[40:43]
  v_mfma_f32_16x16x32_bf16 v[40:43], v[120:123], v[88:91], v[40:43]
  v_mfma_f32_16x16x32_bf16 v[40:43], v[124:127], v[92:95], v[40:43]
  ds_read_b128 v[112:115], v10 offset:28672
  ds_read_b128 v[116:119], v11 offset:28672
  ds_read_b128 v[120:123], v12 offset:28672
  ds_read_b128 v[124:127], v13 offset:28672
  s_waitcnt lgkmcnt(4)
  v_mfma_f32_16x16x32_bf16 v[44:47], v[96:99], v[64:67], 0
  v_mfma_f32_16x16x32_bf16 v[44:47], v[100:103], v[68:71], v[44:47]
  v_mfma_f32_16x16x32_bf16 v[44:47], v[104:107], v[72:75], v[44:47]
  v_mfma_f32_16x16x32_bf16 v[44:47], v[108:111], v[76:79], v[44:47]
  s_waitcnt lgkmcnt(0)
  v_mfma_f32_16x16x32_bf16 v[44:47], v[112:115], v[80:83], v[44:47]
  v_mfma_f32_16x16x32_bf16 v[44:47], v[116:119], v[84:87], v[44:47]
  v_mfma_f32_16x16x32_bf16 v[44:47], v[120:123], v[88:91], v[44:47]
  v_mfma_f32_16x16x32_bf16 v[44:47], v[124:127], v[92:95], v[44:47]
  s_xor_b32 s56, s88, 1062912
  s_waitcnt vmcnt(5)
  buffer_load_dwordx4 v[172:175], v9, s[44:47], s56 offen offset:0 nt
  s_mov_b32 s57, 1035273459
  s_mov_b32 s58, 1069066811
  v_cvt_pk_bf16_f32 v32, v32, v33
  v_and_b32 v33, 0xffff0000, v32
  v_lshlrev_b32 v32, 16, v32
  v_mul_f32 v32, s57, v32
  v_mul_f32 v33, s57, v33
  v_cvt_pk_bf16_f32 v32, v32, v33
  v_and_b32 v33, 0xffff0000, v32
  v_lshlrev_b32 v32, 16, v32
  v_cvt_pk_bf16_f32 v34, v34, v35
  v_and_b32 v35, 0xffff0000, v34
  v_lshlrev_b32 v34, 16, v34
  v_mul_f32 v34, s57, v34
  v_mul_f32 v35, s57, v35
  v_cvt_pk_bf16_f32 v34, v34, v35
  v_and_b32 v35, 0xffff0000, v34
  v_lshlrev_b32 v34, 16, v34
  v_cvt_pk_bf16_f32 v36, v36, v37
  v_and_b32 v37, 0xffff0000, v36
  v_lshlrev_b32 v36, 16, v36
  v_mul_f32 v36, s57, v36
  v_mul_f32 v37, s57, v37
  v_cvt_pk_bf16_f32 v36, v36, v37
  v_and_b32 v37, 0xffff0000, v36
  v_lshlrev_b32 v36, 16, v36
  v_cvt_pk_bf16_f32 v38, v38, v39
  v_and_b32 v39, 0xffff0000, v38
  v_lshlrev_b32 v38, 16, v38
  v_mul_f32 v38, s57, v38
  v_mul_f32 v39, s57, v39
  v_cvt_pk_bf16_f32 v38, v38, v39
  v_and_b32 v39, 0xffff0000, v38
  v_lshlrev_b32 v38, 16, v38
  v_cvt_pk_bf16_f32 v40, v40, v41
  v_and_b32 v41, 0xffff0000, v40
  v_lshlrev_b32 v40, 16, v40
  v_mul_f32 v40, s57, v40
  v_mul_f32 v41, s57, v41
  v_cvt_pk_bf16_f32 v40, v40, v41
  v_and_b32 v41, 0xffff0000, v40
  v_lshlrev_b32 v40, 16, v40
  v_cvt_pk_bf16_f32 v42, v42, v43
  v_and_b32 v43, 0xffff0000, v42
  v_lshlrev_b32 v42, 16, v42
  v_mul_f32 v42, s57, v42
  v_mul_f32 v43, s57, v43
  v_cvt_pk_bf16_f32 v42, v42, v43
  v_and_b32 v43, 0xffff0000, v42
  v_lshlrev_b32 v42, 16, v42
  v_cvt_pk_bf16_f32 v44, v44, v45
  v_and_b32 v45, 0xffff0000, v44
  v_lshlrev_b32 v44, 16, v44
  v_mul_f32 v44, s57, v44
  v_mul_f32 v45, s57, v45
  v_cvt_pk_bf16_f32 v44, v44, v45
  v_and_b32 v45, 0xffff0000, v44
  v_lshlrev_b32 v44, 16, v44
  v_cvt_pk_bf16_f32 v46, v46, v47
  v_and_b32 v47, 0xffff0000, v46
  v_lshlrev_b32 v46, 16, v46
  v_mul_f32 v46, s57, v46
  v_mul_f32 v47, s57, v47
  v_cvt_pk_bf16_f32 v46, v46, v47
  v_and_b32 v47, 0xffff0000, v46
  v_lshlrev_b32 v46, 16, v46
  s_xor_b32 s56, s88, 3317760
  s_waitcnt vmcnt(5)
  buffer_load_dwordx4 v[176:179], v9, s[44:47], s56 offen offset:0 nt
  v_max3_f32 v18, v32, v33, v34
  v_max3_f32 v18, v18, v35, v36
  v_max3_f32 v18, v18, v37, v38
  v_max3_f32 v18, v18, v39, v40
  v_max3_f32 v18, v18, v41, v42
  v_max3_f32 v18, v18, v43, v44
  v_max3_f32 v18, v18, v45, v46
  v_max_f32 v18, v18, v47
  s_nop 1
  v_max_f32_dpp v18, v18, v18 row_ror:8 row_mask:0xf bank_mask:0xf
  v_mov_b32 v20, v18
  s_nop 1
  v_permlane16_swap_b32 v20, v18
  v_max_f32 v18, v18, v20
  v_mov_b32 v20, v18
  s_nop 1
  v_permlane32_swap_b32 v20, v18
  v_max_f32 v18, v18, v20
  v_sub_f32 v32, v32, v18
  v_mul_f32 v32, s58, v32
  v_sub_f32 v33, v33, v18
  v_mul_f32 v33, s58, v33
  v_sub_f32 v34, v34, v18
  v_mul_f32 v34, s58, v34
  v_sub_f32 v35, v35, v18
  v_mul_f32 v35, s58, v35
  v_sub_f32 v36, v36, v18
  v_mul_f32 v36, s58, v36
  v_sub_f32 v37, v37, v18
  v_mul_f32 v37, s58, v37
  v_sub_f32 v38, v38, v18
  v_mul_f32 v38, s58, v38
  v_sub_f32 v39, v39, v18
  v_mul_f32 v39, s58, v39
  v_sub_f32 v40, v40, v18
  v_mul_f32 v40, s58, v40
  v_sub_f32 v41, v41, v18
  v_mul_f32 v41, s58, v41
  v_sub_f32 v42, v42, v18
  v_mul_f32 v42, s58, v42
  v_sub_f32 v43, v43, v18
  v_mul_f32 v43, s58, v43
  v_sub_f32 v44, v44, v18
  v_mul_f32 v44, s58, v44
  v_sub_f32 v45, v45, v18
  v_mul_f32 v45, s58, v45
  v_sub_f32 v46, v46, v18
  v_mul_f32 v46, s58, v46
  v_sub_f32 v47, v47, v18
  v_mul_f32 v47, s58, v47
  s_xor_b32 s56, s88, 3321856
  s_waitcnt vmcnt(5)
  buffer_load_dwordx4 v[180:183], v9, s[44:47], s56 offen offset:0 nt
  v_exp_f32 v32, v32
  v_exp_f32 v33, v33
  v_exp_f32 v34, v34
  v_exp_f32 v35, v35
  v_exp_f32 v36, v36
  v_exp_f32 v37, v37
  v_exp_f32 v38, v38
  v_exp_f32 v39, v39
  v_exp_f32 v40, v40
  v_exp_f32 v41, v41
  v_exp_f32 v42, v42
  v_exp_f32 v43, v43
  v_exp_f32 v44, v44
  v_exp_f32 v45, v45
  v_exp_f32 v46, v46
  v_exp_f32 v47, v47
  v_add_f32 v19, v32, v33
  v_add_f32 v19, v19, v34
  v_add_f32 v19, v19, v35
  v_add_f32 v19, v19, v36
  v_add_f32 v19, v19, v37
  v_add_f32 v19, v19, v38
  v_add_f32 v19, v19, v39
  v_add_f32 v19, v19, v40
  v_add_f32 v19, v19, v41
  v_add_f32 v19, v19, v42
  v_add_f32 v19, v19, v43
  v_add_f32 v19, v19, v44
  v_add_f32 v19, v19, v45
  v_add_f32 v19, v19, v46
  v_add_f32 v19, v19, v47
  s_nop 1
  v_add_f32_dpp v19, v19, v19 row_ror:8 row_mask:0xf bank_mask:0xf
  v_mov_b32 v20, v19
  s_nop 1
  v_permlane16_swap_b32 v20, v19
  v_add_f32 v19, v19, v20
  v_mov_b32 v20, v19
  s_nop 1
  v_permlane32_swap_b32 v20, v19
  v_add_f32 v19, v19, v20
  s_lshl_b32 s59, s63, 6
  v_add_u32 v20, s59, v17
  ds_write_b64 v20, v[18:19]
  s_xor_b32 s56, s88, 3319808
  s_waitcnt vmcnt(5)
  buffer_load_dwordx4 v[184:187], v9, s[44:47], s56 offen offset:0 nt
  v_cvt_pk_bf16_f32 v24, v32, v33
  v_cvt_pk_bf16_f32 v25, v34, v35
  v_cvt_pk_bf16_f32 v26, v36, v37
  v_cvt_pk_bf16_f32 v27, v38, v39
  v_cvt_pk_bf16_f32 v28, v40, v41
  v_cvt_pk_bf16_f32 v29, v42, v43
  v_cvt_pk_bf16_f32 v30, v44, v45
  v_cvt_pk_bf16_f32 v31, v46, v47
  v_and_b32 v64, v15, v24
  v_mov_b32_dpp v68, v24 row_shr:8 row_mask:0xf bank_mask:0xf bound_ctrl:1
  v_mov_b32_dpp v72, v24 row_shl:8 row_mask:0xf bank_mask:0xf bound_ctrl:1
  v_and_b32 v76, v16, v24
  v_and_b32 v65, v15, v25
  v_mov_b32_dpp v69, v25 row_shr:8 row_mask:0xf bank_mask:0xf bound_ctrl:1
  v_mov_b32_dpp v73, v25 row_shl:8 row_mask:0xf bank_mask:0xf bound_ctrl:1
  v_and_b32 v77, v16, v25
  v_and_b32 v66, v15, v26
  v_mov_b32_dpp v70, v26 row_shr:8 row_mask:0xf bank_mask:0xf bound_ctrl:1
  v_mov_b32_dpp v74, v26 row_shl:8 row_mask:0xf bank_mask:0xf bound_ctrl:1
  v_and_b32 v78, v16, v26
  v_and_b32 v67, v15, v27
  v_mov_b32_dpp v71, v27 row_shr:8 row_mask:0xf bank_mask:0xf bound_ctrl:1
  v_mov_b32_dpp v75, v27 row_shl:8 row_mask:0xf bank_mask:0xf bound_ctrl:1
  v_and_b32 v79, v16, v27
  v_and_b32 v80, v15, v28
  v_mov_b32_dpp v84, v28 row_shr:8 row_mask:0xf bank_mask:0xf bound_ctrl:1
  v_mov_b32_dpp v88, v28 row_shl:8 row_mask:0xf bank_mask:0xf bound_ctrl:1
  v_and_b32 v92, v16, v28
  v_and_b32 v81, v15, v29
  v_mov_b32_dpp v85, v29 row_shr:8 row_mask:0xf bank_mask:0xf bound_ctrl:1
  v_mov_b32_dpp v89, v29 row_shl:8 row_mask:0xf bank_mask:0xf bound_ctrl:1
  v_and_b32 v93, v16, v29
  v_and_b32 v82, v15, v30
  v_mov_b32_dpp v86, v30 row_shr:8 row_mask:0xf bank_mask:0xf bound_ctrl:1
  v_mov_b32_dpp v90, v30 row_shl:8 row_mask:0xf bank_mask:0xf bound_ctrl:1
  v_and_b32 v94, v16, v30
  v_and_b32 v83, v15, v31
  v_mov_b32_dpp v87, v31 row_shr:8 row_mask:0xf bank_mask:0xf bound_ctrl:1
  v_mov_b32_dpp v91, v31 row_shl:8 row_mask:0xf bank_mask:0xf bound_ctrl:1
  v_and_b32 v95, v16, v31
  s_xor_b32 s56, s88, 3323904
  s_waitcnt vmcnt(5)
  buffer_load_dwordx4 v[188:191], v9, s[44:47], s56 offen offset:0 nt
  s_mov_b32 s32, s12
  s_mov_b32 s33, s13
  s_mov_b32 s34, 8388608
  s_mov_b32 s35, 0x20000
  s_mov_b32 s36, s20
  s_mov_b32 s37, s21
  s_mov_b32 s38, 7340032
  s_mov_b32 s39, 0x20000
  s_lshr_b32 s52, s2, 3
  s_and_b32 s59, s63, 1
  s_lshl1_add_u32 s52, s52, s59
  s_and_b32 s53, s2, 7
  s_lshr_b32 s57, s63, 1
  s_lshl1_add_u32 s53, s53, s57
  s_lshl_b32 s57, s53, 7
  s_mul_i32 s48, s52, 114688
  s_add_u32 s48, s48, s57
  s_lshl_b32 s49, s52, 17
  s_add_u32 s49, s49, s57
  s_and_b32 s50, s2, 7
  s_lshl_b32 s50, s50, 6
  s_add_u32 s50, s50, s52
  s_and_b32 s51, s53, 1
  s_lshl1_add_u32 s50, s50, s51
  s_lshl_b32 s50, s50, 9
  s_add_u32 s50, s50, 786432
  v_lshrrev_b32 v20, 3, v1
  v_lshlrev_b32 v21, 4, v8
  v_mul_u32_u24 v6, 14336, v20
  v_add_u32 v6, v6, v21
  v_and_b32 v7, 3, v20
  v_lshl_add_u32 v7, v7, 12, v21
  v_and_b32 v20, 4, v20
  v_lshl_add_u32 v7, v20, 14, v7
  v_and_b32 v10, 6, v1
  v_lshlrev_b32 v10, 6, v10
  v_and_b32 v20, 8, v1
  v_lshl_add_u32 v10, v20, 2, v10
  v_and_b32 v21, 1, v1
  v_lshl_add_u32 v10, v21, 6, v10
  v_lshl_add_u32 v10, v2, 4, v10
  v_mov_b32 v21, 1073741824
  v_cmp_gt_u32 vcc, 32, v1
  s_nop 1
  v_cndmask_b32 v10, v21, v10, vcc
  v_and_b32 v21, 1, v1
  v_lshl_add_u32 v11, v2, 1, v21
  v_lshlrev_b32 v11, 4, v11
  s_lshl_b32 s59, s59, 7
  s_add_u32 s59, s59, 152448
  v_add_u32 v11, s59, v11
  v_mul_u32_u24 v5, 528, v8
  v_lshl_add_u32 v5, v2, 7, v5
  v_lshl_add_u32 v5, v20, 3, v5
  s_mul_i32 s57, s63, 4224
  s_add_u32 s57, s57, 131072
  v_add_u32 v5, s57, v5
  s_lshl_b32 s57, s63, 2
  s_add_u32 s57, s57, 152976
  v_mov_b32 v13, s57
  v_mov_b32 v12, 0xfffff000
  v_mov_b32 v20, 152960
  ds_read_b32 v20, v20 offset:12
  s_waitcnt lgkmcnt(0)
  v_readfirstlane_b32 s96, v20
  s_nop 0
  s_bfe_u32 s97, s96, 786432
  s_bfe_u32 s98, s96, 786444
  s_bfe_u32 s99, s96, 786452
  s_bfe_u32 s100, s96, 786438
  s_xor_b32 s56, s88, 4194304
  s_waitcnt vmcnt(5)
  buffer_load_dwordx4 v[192:195], v9, s[44:47], s56 offen offset:0 nt
  v_perm_b32 v96, v132, v128, s60
  v_perm_b32 v100, v132, v128, s61
  v_perm_b32 v104, v133, v129, s60
  v_perm_b32 v108, v133, v129, s61
  v_perm_b32 v112, v134, v130, s60
  v_perm_b32 v116, v134, v130, s61
  v_perm_b32 v120, v135, v131, s60
  v_perm_b32 v124, v135, v131, s61
  v_perm_b32 v97, v140, v136, s60
  v_perm_b32 v101, v140, v136, s61
  v_perm_b32 v105, v141, v137, s60
  v_perm_b32 v109, v141, v137, s61
  v_perm_b32 v113, v142, v138, s60
  v_perm_b32 v117, v142, v138, s61
  v_perm_b32 v121, v143, v139, s60
  v_perm_b32 v125, v143, v139, s61
  s_xor_b32 s56, s88, 4198400
  s_waitcnt vmcnt(5)
  buffer_load_dwordx4 v[196:199], v9, s[44:47], s56 offen offset:0 nt
  v_perm_b32 v98, v148, v144, s60
  v_perm_b32 v102, v148, v144, s61
  v_perm_b32 v106, v149, v145, s60
  v_perm_b32 v110, v149, v145, s61
  v_perm_b32 v114, v150, v146, s60
  v_perm_b32 v118, v150, v146, s61
  v_perm_b32 v122, v151, v147, s60
  v_perm_b32 v126, v151, v147, s61
  v_perm_b32 v99, v156, v152, s60
  v_perm_b32 v103, v156, v152, s61
  v_perm_b32 v107, v157, v153, s60
  v_perm_b32 v111, v157, v153, s61
  v_perm_b32 v115, v158, v154, s60
  v_perm_b32 v119, v158, v154, s61
  v_perm_b32 v123, v159, v155, s60
  v_perm_b32 v127, v159, v155, s61
  v_mfma_f32_16x16x32_bf16 v[48:51], v[96:99], v[64:67], 0
  v_mfma_f32_16x16x32_bf16 v[52:55], v[100:103], v[64:67], 0
  v_mfma_f32_16x16x32_bf16 v[56:59], v[104:107], v[64:67], 0
  v_mfma_f32_16x16x32_bf16 v[60:63], v[108:111], v[64:67], 0
  v_mfma_f32_16x16x32_bf16 v[48:51], v[112:115], v[68:71], v[48:51]
  v_mfma_f32_16x16x32_bf16 v[52:55], v[116:119], v[68:71], v[52:55]
  v_mfma_f32_16x16x32_bf16 v[56:59], v[120:123], v[68:71], v[56:59]
  v_mfma_f32_16x16x32_bf16 v[60:63], v[124:127], v[68:71], v[60:63]
  v_mov_b32 v156, 0
  v_mov_b32 v157, 0
  v_mov_b32 v158, 0
  v_mov_b32 v159, 0
  s_xor_b32 s56, s88, 4196352
  s_waitcnt vmcnt(5)
  buffer_load_dwordx4 v[200:203], v9, s[44:47], s56 offen offset:0 nt
  v_perm_b32 v96, v164, v160, s60
  v_perm_b32 v100, v164, v160, s61
  v_perm_b32 v104, v165, v161, s60
  v_perm_b32 v108, v165, v161, s61
  v_perm_b32 v112, v166, v162, s60
  v_perm_b32 v116, v166, v162, s61
  v_perm_b32 v120, v167, v163, s60
  v_perm_b32 v124, v167, v163, s61
  v_perm_b32 v97, v172, v168, s60
  v_perm_b32 v101, v172, v168, s61
  v_perm_b32 v105, v173, v169, s60
  v_perm_b32 v109, v173, v169, s61
  v_perm_b32 v113, v174, v170, s60
  v_perm_b32 v117, v174, v170, s61
  v_perm_b32 v121, v175, v171, s60
  v_perm_b32 v125, v175, v171, s61
  s_xor_b32 s56, s88, 4200448
  s_waitcnt vmcnt(5)
  buffer_load_dwordx4 v[204:207], v9, s[44:47], s56 offen offset:0 nt
  v_perm_b32 v98, v180, v176, s60
  v_perm_b32 v102, v180, v176, s61
  v_perm_b32 v106, v181, v177, s60
  v_perm_b32 v110, v181, v177, s61
  v_perm_b32 v114, v182, v178, s60
  v_perm_b32 v118, v182, v178, s61
  v_perm_b32 v122, v183, v179, s60
  v_perm_b32 v126, v183, v179, s61
  s_xor_b32 s56, s88, 6455296
  s_waitcnt vmcnt(5)
  buffer_load_dwordx4 v[208:211], v9, s[44:47], s56 offen offset:0 nt
  s_xor_b32 s56, s88, 6459392
  s_waitcnt vmcnt(5)
  buffer_load_dwordx4 v[212:215], v9, s[44:47], s56 offen offset:0 nt
  v_perm_b32 v99, v188, v184, s60
  v_perm_b32 v103, v188, v184, s61
  v_perm_b32 v107, v189, v185, s60
  v_perm_b32 v111, v189, v185, s61
  v_perm_b32 v115, v190, v186, s60
  v_perm_b32 v119, v190, v186, s61
  v_perm_b32 v123, v191, v187, s60
  v_perm_b32 v127, v191, v187, s61
  v_mfma_f32_16x16x32_bf16 v[48:51], v[96:99], v[72:75], v[48:51]
  v_mfma_f32_16x16x32_bf16 v[52:55], v[100:103], v[72:75], v[52:55]
  v_mfma_f32_16x16x32_bf16 v[56:59], v[104:107], v[72:75], v[56:59]
  v_mfma_f32_16x16x32_bf16 v[60:63], v[108:111], v[72:75], v[60:63]
  v_mfma_f32_16x16x32_bf16 v[48:51], v[112:115], v[76:79], v[48:51]
  v_mfma_f32_16x16x32_bf16 v[52:55], v[116:119], v[76:79], v[52:55]
  v_mfma_f32_16x16x32_bf16 v[56:59], v[120:123], v[76:79], v[56:59]
  v_mfma_f32_16x16x32_bf16 v[60:63], v[124:127], v[76:79], v[60:63]
  s_xor_b32 s56, s88, 6457344
  s_waitcnt vmcnt(5)
  buffer_load_dwordx4 v[216:219], v9, s[44:47], s56 offen offset:0 nt
  s_xor_b32 s56, s88, 6461440
  s_waitcnt vmcnt(5)
  buffer_load_dwordx4 v[220:223], v9, s[44:47], s56 offen offset:0 nt
  v_perm_b32 v96, v196, v192, s60
  v_perm_b32 v100, v196, v192, s61
  v_perm_b32 v104, v197, v193, s60
  v_perm_b32 v108, v197, v193, s61
  v_perm_b32 v112, v198, v194, s60
  v_perm_b32 v116, v198, v194, s61
  v_perm_b32 v120, v199, v195, s60
  v_perm_b32 v124, v199, v195, s61
  s_xor_b32 s56, s88, 5251072
  s_waitcnt vmcnt(5)
  buffer_load_dwordx4 v[224:227], v9, s[44:47], s56 offen offset:0 nt
  s_xor_b32 s56, s88, 5255168
  s_waitcnt vmcnt(5)
  buffer_load_dwordx4 v[228:231], v9, s[44:47], s56 offen offset:0 nt
  v_perm_b32 v97, v204, v200, s60
  v_perm_b32 v101, v204, v200, s61
  v_perm_b32 v105, v205, v201, s60
  v_perm_b32 v109, v205, v201, s61
  v_perm_b32 v113, v206, v202, s60
  v_perm_b32 v117, v206, v202, s61
  v_perm_b32 v121, v207, v203, s60
  v_perm_b32 v125, v207, v203, s61
  v_lshrrev_b32 v21, 5, v1
  v_add_lshl_u32 v14, v21, v1, 4
  s_mul_i32 s57, s63, 1056
  s_add_u32 s57, s57, 131072
  v_add_u32 v14, s57, v14
  v_mul_u32_u24 v15, 4224, v2
  v_add_u32 v15, 135276, v15
  v_lshlrev_b32 v16, 10, v2
  v_lshl_add_u32 v16, v3, 3, v16
  s_and_b32 s57, s2, 7
  s_bfe_u32 s59, s2, 0x20003
  s_lshl2_add_u32 s57, s57, s59
  s_lshl2_add_u32 s57, s57, s63
  s_lshl_b32 s57, s57, 5
  s_lshr_b32 s59, s2, 5
  s_add_u32 s57, s57, s59
  s_lshl_b32 s93, s57, 7
  s_add_u32 s93, s93, 786432
  v_mov_b32 v22, s96
  v_lshlrev_b32 v23, 1, v3
  v_alignbit_b32 v22, v22, v22, v23
  v_and_b32 v18, 0x10001, v22
  v_alignbit_b32 v19, v22, v22, 1
  v_and_b32 v19, 0x10001, v19
  s_lshl_b32 s57, s63, 4
  s_add_u32 s57, s57, 152192
  v_lshl_add_u32 v21, v21, 3, s57
  v_mov_b32 v17, 0xfffefffe
  v_mov_b32 v22, 152960
L_mlf:
  ds_read_b32 v36, v21 offset:0
  ds_read_b32 v38, v21 offset:64
  ds_read_b32 v40, v21 offset:128
  ds_read_b32 v42, v21 offset:192
  ds_read_b32 v37, v22 offset:8
  s_waitcnt lgkmcnt(0)
  v_max3_u32 v20, v36, v37, v38
  v_max3_u32 v20, v20, v40, v42
  v_cmp_eq_u32 vcc, -1, v20
  s_nop 0
  s_cbranch_vccz L_mlf_ok
  s_sub_u32 s62, s62, 1
  s_cmp_gt_i32 s62, 0
  s_cbranch_scc1 L_mlf
L_mlf_ok:
  v_readfirstlane_b32 s92, v37
  v_max3_f32 v20, v36, v38, v40
  v_max_f32 v20, v20, v42
  v_mul_f32 v20, s58, v20
  v_ceil_f32 v20, v20
  v_fma_f32 v36, v36, s58, -v20
  v_exp_f32 v36, v36
  s_nop 0
  v_mov_b32 v37, v36
  v_fma_f32 v38, v38, s58, -v20
  v_exp_f32 v38, v38
  s_nop 0
  v_mov_b32 v39, v38
  v_fma_f32 v40, v40, s58, -v20
  v_exp_f32 v40, v40
  s_nop 0
  v_mov_b32 v41, v40
  v_fma_f32 v42, v42, s58, -v20
  v_exp_f32 v42, v42
  s_nop 0
  v_mov_b32 v43, v42
  s_xor_b32 s56, s88, 5253120
  s_waitcnt vmcnt(5)
  buffer_load_dwordx4 v[232:235], v9, s[44:47], s56 offen offset:0 nt
  s_xor_b32 s56, s88, 5257216
  s_waitcnt vmcnt(5)
  buffer_load_dwordx4 v[236:239], v9, s[44:47], s56 offen offset:0 nt
  v_perm_b32 v98, v212, v208, s60
  v_perm_b32 v102, v212, v208, s61
  v_perm_b32 v106, v213, v209, s60
  v_perm_b32 v110, v213, v209, s61
  v_perm_b32 v114, v214, v210, s60
  v_perm_b32 v118, v214, v210, s61
  v_perm_b32 v122, v215, v211, s60
  v_perm_b32 v126, v215, v211, s61
  s_xor_b32 s56, s88, 7512064
  s_waitcnt vmcnt(5)
  buffer_load_dwordx4 v[240:243], v9, s[44:47], s56 offen offset:0 nt
  s_xor_b32 s56, s88, 7516160
  s_waitcnt vmcnt(5)
  buffer_load_dwordx4 v[244:247], v9, s[44:47], s56 offen offset:0 nt
  v_perm_b32 v99, v220, v216, s60
  v_perm_b32 v103, v220, v216, s61
  v_perm_b32 v107, v221, v217, s60
  v_perm_b32 v111, v221, v217, s61
  v_perm_b32 v115, v222, v218, s60
  v_perm_b32 v119, v222, v218, s61
  v_perm_b32 v123, v223, v219, s60
  v_perm_b32 v127, v223, v219, s61
  v_mfma_f32_16x16x32_bf16 v[48:51], v[96:99], v[80:83], v[48:51]
  v_mfma_f32_16x16x32_bf16 v[52:55], v[100:103], v[80:83], v[52:55]
  v_mfma_f32_16x16x32_bf16 v[56:59], v[104:107], v[80:83], v[56:59]
  v_mfma_f32_16x16x32_bf16 v[60:63], v[108:111], v[80:83], v[60:63]
  v_mfma_f32_16x16x32_bf16 v[48:51], v[112:115], v[84:87], v[48:51]
  v_mfma_f32_16x16x32_bf16 v[52:55], v[116:119], v[84:87], v[52:55]
  v_mfma_f32_16x16x32_bf16 v[56:59], v[120:123], v[84:87], v[56:59]
  v_mfma_f32_16x16x32_bf16 v[60:63], v[124:127], v[84:87], v[60:63]
  s_xor_b32 s56, s88, 7514112
  s_waitcnt vmcnt(5)
  buffer_load_dwordx4 v[248:251], v9, s[44:47], s56 offen offset:0 nt
  s_xor_b32 s56, s88, 7518208
  s_waitcnt vmcnt(5)
  buffer_load_dwordx4 v[252:255], v9, s[44:47], s56 offen offset:0 nt
  v_perm_b32 v96, v228, v224, s60
  v_perm_b32 v100, v228, v224, s61
  v_perm_b32 v104, v229, v225, s60
  v_perm_b32 v108, v229, v225, s61
  v_perm_b32 v112, v230, v226, s60
  v_perm_b32 v116, v230, v226, s61
  v_perm_b32 v120, v231, v227, s60
  v_perm_b32 v124, v231, v227, s61
  s_waitcnt vmcnt(5)
  buffer_load_dwordx4 v[128:131], v6, s[36:39], s48 offen offset:0 nt
  s_waitcnt vmcnt(5)
  buffer_load_dwordx4 v[132:135], v6, s[36:39], s48 offen offset:2048 nt
  s_add_u32 s48, s48, 4096
  v_perm_b32 v97, v236, v232, s60
  v_perm_b32 v101, v236, v232, s61
  v_perm_b32 v105, v237, v233, s60
  v_perm_b32 v109, v237, v233, s61
  v_perm_b32 v113, v238, v234, s60
  v_perm_b32 v117, v238, v234, s61
  v_perm_b32 v121, v239, v235, s60
  v_perm_b32 v125, v239, v235, s61
  s_waitcnt vmcnt(5)
  buffer_load_dwordx4 v[136:139], v6, s[36:39], s48 offen offset:0 nt
  s_waitcnt vmcnt(5)
  buffer_load_dwordx4 v[140:143], v6, s[36:39], s48 offen offset:2048 nt
  s_add_u32 s48, s48, 4096
  v_perm_b32 v98, v244, v240, s60
  v_perm_b32 v102, v244, v240, s61
  v_perm_b32 v106, v245, v241, s60
  v_perm_b32 v110, v245, v241, s61
  v_perm_b32 v114, v246, v242, s60
  v_perm_b32 v118, v246, v242, s61
  v_perm_b32 v122, v247, v243, s60
  v_perm_b32 v126, v247, v243, s61
  s_waitcnt vmcnt(4)
  v_perm_b32 v99, v252, v248, s60
  v_perm_b32 v115, v254, v250, s60
  v_perm_b32 v103, v252, v248, s61
  v_perm_b32 v119, v254, v250, s61
  v_mfma_f32_16x16x32_bf16 v[48:51], v[96:99], v[88:91], v[48:51]
  v_mfma_f32_16x16x32_bf16 v[48:51], v[112:115], v[92:95], v[48:51]
  v_perm_b32 v107, v253, v249, s60
  v_perm_b32 v123, v255, v251, s60
  v_mfma_f32_16x16x32_bf16 v[52:55], v[100:103], v[88:91], v[52:55]
  v_mfma_f32_16x16x32_bf16 v[52:55], v[116:119], v[92:95], v[52:55]
  v_perm_b32 v111, v253, v249, s61
  v_perm_b32 v127, v255, v251, s61
  v_mfma_f32_16x16x32_bf16 v[56:59], v[104:107], v[88:91], v[56:59]
  v_mfma_f32_16x16x32_bf16 v[56:59], v[120:123], v[92:95], v[56:59]
  v_mfma_f32_16x16x32_bf16 v[60:63], v[108:111], v[88:91], v[60:63]
  v_mfma_f32_16x16x32_bf16 v[60:63], v[124:127], v[92:95], v[60:63]
  ds_write_b128 v5, v[48:51] offset:0
  s_nop 0
  ds_write_b128 v5, v[52:55] offset:16
  s_nop 2
  ds_write_b128 v5, v[56:59] offset:32
  s_nop 0
  ds_write_b128 v5, v[60:63] offset:48
L_or:
  ds_read_b32 v20, v15
  ds_read_b128 v[96:99], v14 offset:0
  ds_read_b128 v[100:103], v14 offset:4224
  ds_read_b128 v[104:107], v14 offset:8448
  ds_read_b128 v[108:111], v14 offset:12672
  s_waitcnt lgkmcnt(4)
  v_cmp_eq_u32 vcc, -1, v20
  s_nop 0
  s_cbranch_vccz L_or_ok
  s_sub_u32 s62, s62, 1
  s_cmp_gt_i32 s62, 0
  s_cbranch_scc1 L_or
L_or_ok:
  s_waitcnt lgkmcnt(3)
  v_pk_mul_f32 v[24:25], v[96:97], v[36:37]
  v_pk_mul_f32 v[26:27], v[98:99], v[36:37]
  s_waitcnt lgkmcnt(2)
  v_pk_fma_f32 v[24:25], v[100:101], v[38:39], v[24:25]
  v_pk_fma_f32 v[26:27], v[102:103], v[38:39], v[26:27]
  s_waitcnt lgkmcnt(1)
  v_pk_fma_f32 v[24:25], v[104:105], v[40:41], v[24:25]
  v_pk_fma_f32 v[26:27], v[106:107], v[40:41], v[26:27]
  s_waitcnt lgkmcnt(0)
  v_pk_fma_f32 v[24:25], v[108:109], v[42:43], v[24:25]
  v_pk_fma_f32 v[26:27], v[110:111], v[42:43], v[26:27]
  v_add_u32 v24, 0x10000, v24
  v_add_u32 v25, 0x10000, v25
  v_add_u32 v26, 0x10000, v26
  v_add_u32 v27, 0x10000, v27
  v_perm_b32 v24, v25, v24, s61
  v_perm_b32 v25, v27, v26, s61
  v_and_or_b32 v24, v24, v17, v18
  v_and_or_b32 v25, v25, v17, v19
  s_cmp_eq_u32 s92, 1
  s_cbranch_scc0 L_stof
  buffer_store_dwordx2 v[24:25], v16, s[28:31], s93 offen
  s_branch L_stod
L_stof:
  buffer_store_dwordx2 v[24:25], v16, s[28:31], s93 offen sc1
L_stod:
  s_waitcnt vmcnt(1)
  s_waitcnt vmcnt(0)
  s_waitcnt vmcnt(6)
  buffer_load_dwordx4 v[144:147], v6, s[36:39], s48 offen offset:0 nt
  s_waitcnt vmcnt(6)
  buffer_load_dwordx4 v[148:151], v6, s[36:39], s48 offen offset:2048 nt
  s_add_u32 s48, s48, 4096
  s_waitcnt vmcnt(6)
  buffer_load_dwordx4 v[152:155], v6, s[36:39], s48 offen offset:0 nt
  s_waitcnt vmcnt(6)
  buffer_load_dwordx4 v[160:163], v7, s[32:35], s49 offen offset:0 nt
  s_add_u32 s49, s49, 16384
  s_waitcnt vmcnt(6)
  buffer_load_dwordx4 v[164:167], v7, s[32:35], s49 offen offset:0 nt
  s_add_u32 s49, s49, 16384
  s_waitcnt vmcnt(6)
  buffer_load_dwordx4 v[168:171], v7, s[32:35], s49 offen offset:0 nt
  s_add_u32 s49, s49, 16384
  s_waitcnt vmcnt(5)
  buffer_load_dwordx4 v[172:175], v7, s[32:35], s49 offen offset:0 nt
  s_sub_u32 s49, s49, 49152
  s_waitcnt vmcnt(5)
  buffer_load_dwordx4 v[176:179], v7, s[32:35], s49 offen offset:2048 nt
  s_add_u32 s49, s49, 16384
  s_waitcnt vmcnt(5)
  buffer_load_dwordx4 v[180:183], v7, s[32:35], s49 offen offset:2048 nt
  s_add_u32 s49, s49, 16384
  s_waitcnt vmcnt(5)
  buffer_load_dwordx4 v[184:187], v7, s[32:35], s49 offen offset:2048 nt
  s_add_u32 s49, s49, 16384
  s_waitcnt vmcnt(5)
  buffer_load_dwordx4 v[188:191], v7, s[32:35], s49 offen offset:2048 nt
  ds_write_b32 v13, v13
L_varend:
  s_setprio 3
L_hw:
  ds_read_b128 v[32:35], v11
  s_waitcnt lgkmcnt(0)
  v_max3_u32 v20, v32, v33, v34
  v_max_u32 v20, v20, v35
  v_cmp_eq_u32 vcc, -1, v20
  s_nop 0
  s_cbranch_vccz L_hw_ok
  s_sleep 1
  s_sub_u32 s62, s62, 1
  s_cmp_gt_i32 s62, 0
  s_cbranch_scc1 L_hw
L_hw_ok:
  s_waitcnt vmcnt(8)
  v_perm_b32 v96, v132, v128, s60
  v_perm_b32 v100, v132, v128, s61
  v_perm_b32 v104, v133, v129, s60
  v_perm_b32 v108, v133, v129, s61
  v_perm_b32 v112, v134, v130, s60
  v_perm_b32 v116, v134, v130, s61
  v_perm_b32 v120, v135, v131, s60
  v_perm_b32 v124, v135, v131, s61
  v_perm_b32 v97, v140, v136, s60
  v_perm_b32 v101, v140, v136, s61
  v_perm_b32 v105, v141, v137, s60
  v_perm_b32 v109, v141, v137, s61
  v_perm_b32 v113, v142, v138, s60
  v_perm_b32 v117, v142, v138, s61
  v_perm_b32 v121, v143, v139, s60
  v_perm_b32 v125, v143, v139, s61
  v_perm_b32 v98, v148, v144, s60
  v_perm_b32 v102, v148, v144, s61
  v_perm_b32 v106, v149, v145, s60
  v_perm_b32 v110, v149, v145, s61
  v_perm_b32 v114, v150, v146, s60
  v_perm_b32 v118, v150, v146, s61
  v_perm_b32 v122, v151, v147, s60
  v_perm_b32 v126, v151, v147, s61
  v_perm_b32 v99, v156, v152, s60
  v_perm_b32 v103, v156, v152, s61
  v_perm_b32 v107, v157, v153, s60
  v_perm_b32 v111, v157, v153, s61
  v_perm_b32 v115, v158, v154, s60
  v_perm_b32 v119, v158, v154, s61
  v_perm_b32 v123, v159, v155, s60
  v_perm_b32 v127, v159, v155, s61
  v_mfma_f32_16x16x32_bf16 v[64:67], v[32:35], v[96:99], 0
  v_mfma_f32_16x16x32_bf16 v[68:71], v[32:35], v[100:103], 0
  v_mfma_f32_16x16x32_bf16 v[72:75], v[32:35], v[104:107], 0
  v_mfma_f32_16x16x32_bf16 v[76:79], v[32:35], v[108:111], 0
  v_mfma_f32_16x16x32_bf16 v[80:83], v[32:35], v[112:115], 0
  v_mfma_f32_16x16x32_bf16 v[84:87], v[32:35], v[116:119], 0
  v_mfma_f32_16x16x32_bf16 v[88:91], v[32:35], v[120:123], 0
  v_mfma_f32_16x16x32_bf16 v[92:95], v[32:35], v[124:127], 0
  s_nop 0
  v_add_f32_dpp v20, v65, v64 row_ror:8 row_mask:0xf bank_mask:0x3
  s_nop 4
  v_add_f32_dpp v22, v88, v89 row_ror:8 row_mask:0xf bank_mask:0xc
  v_add_f32_dpp v21, v69, v68 row_ror:8 row_mask:0xf bank_mask:0x3
  v_add_f32_dpp v23, v92, v93 row_ror:8 row_mask:0xf bank_mask:0xc
  v_add_f32_dpp v22, v73, v72 row_ror:8 row_mask:0xf bank_mask:0x3
  v_add_f32_dpp v20, v80, v81 row_ror:8 row_mask:0xf bank_mask:0xc
  v_add_f32_dpp v23, v77, v76 row_ror:8 row_mask:0xf bank_mask:0x3
  v_add_f32_dpp v21, v84, v85 row_ror:8 row_mask:0xf bank_mask:0xc
  s_waitcnt vmcnt(6)
  v_perm_b32 v96, v164, v160, s60
  v_perm_b32 v100, v164, v160, s61
  v_perm_b32 v104, v165, v161, s60
  v_perm_b32 v108, v165, v161, s61
  v_perm_b32 v112, v166, v162, s60
  v_perm_b32 v116, v166, v162, s61
  v_perm_b32 v120, v167, v163, s60
  v_perm_b32 v124, v167, v163, s61
  s_waitcnt vmcnt(4)
  v_perm_b32 v97, v172, v168, s60
  v_perm_b32 v101, v172, v168, s61
  v_perm_b32 v105, v173, v169, s60
  v_perm_b32 v109, v173, v169, s61
  v_perm_b32 v113, v174, v170, s60
  v_perm_b32 v117, v174, v170, s61
  v_perm_b32 v121, v175, v171, s60
  v_perm_b32 v125, v175, v171, s61
  s_waitcnt vmcnt(2)
  v_perm_b32 v98, v180, v176, s60
  v_perm_b32 v102, v180, v176, s61
  v_perm_b32 v106, v181, v177, s60
  v_perm_b32 v110, v181, v177, s61
  v_perm_b32 v114, v182, v178, s60
  v_perm_b32 v118, v182, v178, s61
  v_perm_b32 v122, v183, v179, s60
  v_perm_b32 v126, v183, v179, s61
  s_waitcnt vmcnt(1)
  ds_read_b128 v[32:35], v11 offset:256
  s_waitcnt vmcnt(0)
  v_perm_b32 v99, v188, v184, s60
  v_perm_b32 v123, v191, v187, s60
  v_perm_b32 v103, v188, v184, s61
  v_perm_b32 v127, v191, v187, s61
  v_perm_b32 v107, v189, v185, s60
  v_perm_b32 v115, v190, v186, s60
  v_perm_b32 v111, v189, v185, s61
  v_perm_b32 v119, v190, v186, s61
L_ow:
  s_waitcnt lgkmcnt(0)
  v_max3_u32 v24, v32, v33, v34
  v_max_u32 v24, v24, v35
  v_cmp_eq_u32 vcc, -1, v24
  s_nop 0
  s_cbranch_vccz L_ow_ok
  ds_read_b128 v[32:35], v11 offset:256
  s_sub_u32 s62, s62, 1
  s_cmp_gt_i32 s62, 0
  s_cbranch_scc1 L_ow
  s_waitcnt lgkmcnt(0)
L_ow_ok:
  v_mfma_f32_16x16x32_bf16 v[64:67], v[32:35], v[96:99], 0
  v_mfma_f32_16x16x32_bf16 v[88:91], v[32:35], v[120:123], 0
  v_mfma_f32_16x16x32_bf16 v[68:71], v[32:35], v[100:103], 0
  v_mfma_f32_16x16x32_bf16 v[92:95], v[32:35], v[124:127], 0
  v_mfma_f32_16x16x32_bf16 v[72:75], v[32:35], v[104:107], 0
  v_mfma_f32_16x16x32_bf16 v[80:83], v[32:35], v[112:115], 0
  v_mfma_f32_16x16x32_bf16 v[76:79], v[32:35], v[108:111], 0
  v_mfma_f32_16x16x32_bf16 v[84:87], v[32:35], v[116:119], 0
  s_nop 0
  v_add_f32_dpp v20, v65, v64 row_ror:8 row_mask:0x1 bank_mask:0x3
  v_add_f32_dpp v22, v88, v89 row_ror:8 row_mask:0x1 bank_mask:0xc
  v_add_f32_dpp v21, v69, v68 row_ror:8 row_mask:0x1 bank_mask:0x3
  v_add_f32_dpp v23, v92, v93 row_ror:8 row_mask:0x1 bank_mask:0xc
  v_add_f32_dpp v22, v73, v72 row_ror:8 row_mask:0x1 bank_mask:0x3
  v_add_f32_dpp v20, v80, v81 row_ror:8 row_mask:0x1 bank_mask:0xc
  v_add_f32_dpp v23, v77, v76 row_ror:8 row_mask:0x1 bank_mask:0x3
  v_add_f32_dpp v21, v84, v85 row_ror:8 row_mask:0x1 bank_mask:0xc
  s_cmp_eq_u32 s92, 1
  v_add_u32 v20, 2048, v20
  v_add_u32 v21, 2048, v21
  v_add_u32 v22, 2048, v22
  v_add_u32 v23, 2048, v23
  v_and_or_b32 v20, v20, v12, s97
  v_and_or_b32 v21, v21, v12, s98
  v_and_or_b32 v22, v22, v12, s99
  v_and_or_b32 v23, v23, v12, s100
  s_cbranch_scc0 L_sfar
  buffer_store_dwordx4 v[20:23], v10, s[28:31], s50 offen
  s_endpgm
L_sfar:
  buffer_store_dwordx4 v[20:23], v10, s[28:31], s50 offen sc1
  s_endpgm
L_light:
  s_add_u32 m0, s55, 0
  s_xor_b32 s56, s88, 0
  s_waitcnt vmcnt(5)
  buffer_load_dwordx4 v16, s[40:43], s56 offen offset:0 nt lds
  s_add_u32 m0, s55, 1024
  s_xor_b32 s56, s88, 4096
  s_waitcnt vmcnt(5)
  buffer_load_dwordx4 v17, s[40:43], s56 offen offset:0 nt lds
  s_barrier
  s_add_u32 m0, s55, 2048
  s_xor_b32 s56, s88, 2048
  s_waitcnt vmcnt(5)
  buffer_load_dwordx4 v18, s[40:43], s56 offen offset:0 nt lds
  s_add_u32 m0, s55, 3072
  s_xor_b32 s56, s88, 6144
  s_waitcnt vmcnt(5)
  buffer_load_dwordx4 v19, s[40:43], s56 offen offset:0 nt lds
  v_mov_b32 v20, 152960
  ds_write_b32 v20, v20 offset:56
  s_add_u32 m0, s55, 4096
  s_xor_b32 s56, s88, 2260992
  s_waitcnt vmcnt(5)
  buffer_load_dwordx4 v16, s[40:43], s56 offen offset:0 nt lds
  s_add_u32 m0, s55, 5120
  s_xor_b32 s56, s88, 2265088
  s_waitcnt vmcnt(5)
  buffer_load_dwordx4 v17, s[40:43], s56 offen offset:0 nt lds
  s_add_u32 m0, s55, 6144
  s_xor_b32 s56, s88, 2263040
  s_waitcnt vmcnt(5)
  buffer_load_dwordx4 v18, s[40:43], s56 offen offset:0 nt lds
  s_add_u32 m0, s55, 7168
  s_xor_b32 s56, s88, 2267136
  s_waitcnt vmcnt(5)
  buffer_load_dwordx4 v19, s[40:43], s56 offen offset:0 nt lds
  s_add_u32 m0, s55, 8192
  s_xor_b32 s56, s88, 1056768
  s_waitcnt vmcnt(5)
  buffer_load_dwordx4 v16, s[40:43], s56 offen offset:0 nt lds
  s_add_u32 m0, s55, 9216
  s_xor_b32 s56, s88, 1060864
  s_waitcnt vmcnt(5)
  buffer_load_dwordx4 v17, s[40:43], s56 offen offset:0 nt lds
  v_mov_b32 v20, 152960
L_xw0:
  ds_read_b32 v21, v20 offset:0
  s_waitcnt lgkmcnt(0)
  v_cmp_eq_u32 vcc, -1, v21
  s_nop 0
  s_cbranch_vccz L_xw0_ok
  s_sleep 1
  s_sub_u32 s62, s62, 1
  s_cmp_gt_i32 s62, 0
  s_cbranch_scc1 L_xw0
L_xw0_ok:
  ds_read_b128 v[32:35], v12
  s_waitcnt lgkmcnt(0)
  v_perm_b32 v96, v132, v128, s60
  v_perm_b32 v100, v132, v128, s61
  v_perm_b32 v104, v133, v129, s60
  v_perm_b32 v108, v133, v129, s61
  v_perm_b32 v112, v134, v130, s60
  v_perm_b32 v116, v134, v130, s61
  v_perm_b32 v120, v135, v131, s60
  v_perm_b32 v124, v135, v131, s61
  v_perm_b32 v97, v140, v136, s60
  v_perm_b32 v101, v140, v136, s61
  v_perm_b32 v105, v141, v137, s60
  v_perm_b32 v109, v141, v137, s61
  v_perm_b32 v113, v142, v138, s60
  v_perm_b32 v117, v142, v138, s61
  v_perm_b32 v121, v143, v139, s60
  v_perm_b32 v125, v143, v139, s61
  s_add_u32 m0, s55, 10240
  s_xor_b32 s56, s88, 1058816
  s_waitcnt vmcnt(5)
  buffer_load_dwordx4 v18, s[40:43], s56 offen offset:0 nt lds
  v_perm_b32 v98, v148, v144, s60
  v_perm_b32 v102, v148, v144, s61
  v_perm_b32 v106, v149, v145, s60
  v_perm_b32 v110, v149, v145, s61
  v_perm_b32 v114, v150, v146, s60
  v_perm_b32 v118, v150, v146, s61
  v_perm_b32 v122, v151, v147, s60
  v_perm_b32 v126, v151, v147, s61
  v_perm_b32 v99, v156, v152, s60
  v_perm_b32 v103, v156, v152, s61
  v_perm_b32 v107, v157, v153, s60
  v_perm_b32 v111, v157, v153, s61
  v_perm_b32 v115, v158, v154, s60
  v_perm_b32 v119, v158, v154, s61
  v_perm_b32 v123, v159, v155, s60
  v_perm_b32 v127, v159, v155, s61
  v_mfma_f32_16x16x32_bf16 v[64:67], v[32:35], v[96:99], 0
  v_mfma_f32_16x16x32_bf16 v[68:71], v[32:35], v[100:103], 0
  v_mfma_f32_16x16x32_bf16 v[72:75], v[32:35], v[104:107], 0
  v_mfma_f32_16x16x32_bf16 v[76:79], v[32:35], v[108:111], 0
  v_mfma_f32_16x16x32_bf16 v[80:83], v[32:35], v[112:115], 0
  v_mfma_f32_16x16x32_bf16 v[84:87], v[32:35], v[116:119], 0
  v_mfma_f32_16x16x32_bf16 v[88:91], v[32:35], v[120:123], 0
  v_mfma_f32_16x16x32_bf16 v[92:95], v[32:35], v[124:127], 0
  s_add_u32 m0, s55, 11264
  s_xor_b32 s56, s88, 1062912
  s_waitcnt vmcnt(5)
  buffer_load_dwordx4 v19, s[40:43], s56 offen offset:0 nt lds
  v_mov_b32 v20, v64
  v_mov_b32 v21, v68
  v_mov_b32 v22, v72
  v_mov_b32 v23, v76
  v_mov_b32_dpp v20, v80 quad_perm:[0,1,2,3] row_mask:0x2 bank_mask:0xf
  v_mov_b32_dpp v21, v84 quad_perm:[0,1,2,3] row_mask:0x2 bank_mask:0xf
  v_mov_b32_dpp v22, v88 quad_perm:[0,1,2,3] row_mask:0x2 bank_mask:0xf
  v_mov_b32_dpp v23, v92 quad_perm:[0,1,2,3] row_mask:0x2 bank_mask:0xf
  s_mov_b32 exec_hi, 0
  ds_write_b128 v14, v[20:23] offset:0
  s_mov_b64 exec, -1
  s_add_u32 m0, s55, 12288
  s_xor_b32 s56, s88, 3317760
  s_waitcnt vmcnt(5)
  buffer_load_dwordx4 v16, s[40:43], s56 offen offset:0 nt lds
  s_add_u32 m0, s55, 13312
  s_xor_b32 s56, s88, 3321856
  s_waitcnt vmcnt(5)
  buffer_load_dwordx4 v17, s[40:43], s56 offen offset:0 nt lds
  s_add_u32 m0, s55, 14336
  s_xor_b32 s56, s88, 3319808
  s_waitcnt vmcnt(5)
  buffer_load_dwordx4 v18, s[40:43], s56 offen offset:0 nt lds
  s_add_u32 m0, s55, 15360
  s_xor_b32 s56, s88, 3323904
  s_waitcnt vmcnt(5)
  buffer_load_dwordx4 v19, s[40:43], s56 offen offset:0 nt lds
  v_and_b32 v14, 3, v3
  v_lshlrev_b32 v14, 2, v14
  v_lshrrev_b32 v15, 2, v3
  v_add_u32 v14, v14, v15
  v_lshlrev_b32 v14, 8, v14
  v_add_u32 v14, s55, v14
  v_xor_b32 v15, v2, v3
  v_xor_b32 v10, 0, v15
  v_lshl_add_u32 v10, v10, 4, v14
  v_xor_b32 v11, 4, v15
  v_lshl_add_u32 v11, v11, 4, v14
  v_xor_b32 v12, 8, v15
  v_lshl_add_u32 v12, v12, 4, v14
  v_xor_b32 v13, 12, v15
  v_lshl_add_u32 v13, v13, 4, v14
  s_add_u32 m0, s55, 16384
  s_xor_b32 s56, s88, 4194304
  s_waitcnt vmcnt(5)
  buffer_load_dwordx4 v16, s[40:43], s56 offen offset:0 nt lds
  s_add_u32 m0, s55, 17408
  s_xor_b32 s56, s88, 4198400
  s_waitcnt vmcnt(5)
  buffer_load_dwordx4 v17, s[40:43], s56 offen offset:0 nt lds
  s_add_u32 m0, s55, 18432
  s_xor_b32 s56, s88, 4196352
  s_waitcnt vmcnt(5)
  buffer_load_dwordx4 v18, s[40:43], s56 offen offset:0 nt lds
  s_add_u32 m0, s55, 19456
  s_xor_b32 s56, s88, 4200448
  s_waitcnt vmcnt(5)
  buffer_load_dwordx4 v19, s[40:43], s56 offen offset:0 nt lds
  s_add_u32 m0, s55, 20480
  s_xor_b32 s56, s88, 6455296
  s_waitcnt vmcnt(5)
  buffer_load_dwordx4 v16, s[40:43], s56 offen offset:0 nt lds
  s_add_u32 m0, s55, 21504
  s_xor_b32 s56, s88, 6459392
  s_waitcnt vmcnt(5)
  buffer_load_dwordx4 v17, s[40:43], s56 offen offset:0 nt lds
  s_add_u32 m0, s55, 22528
  s_xor_b32 s56, s88, 6457344
  s_waitcnt vmcnt(5)
  buffer_load_dwordx4 v18, s[40:43], s56 offen offset:0 nt lds
  s_add_u32 m0, s55, 23552
  s_xor_b32 s56, s88, 6461440
  s_waitcnt vmcnt(5)
  buffer_load_dwordx4 v19, s[40:43], s56 offen offset:0 nt lds
  s_add_u32 m0, s55, 24576
  s_xor_b32 s56, s88, 5251072
  s_waitcnt vmcnt(5)
  buffer_load_dwordx4 v16, s[40:43], s56 offen offset:0 nt lds
  s_add_u32 m0, s55, 25600
  s_xor_b32 s56, s88, 5255168
  s_waitcnt vmcnt(5)
  buffer_load_dwordx4 v17, s[40:43], s56 offen offset:0 nt lds
  s_add_u32 m0, s55, 26624
  s_xor_b32 s56, s88, 5253120
  s_waitcnt vmcnt(5)
  buffer_load_dwordx4 v18, s[40:43], s56 offen offset:0 nt lds
  s_add_u32 m0, s55, 27648
  s_xor_b32 s56, s88, 5257216
  s_waitcnt vmcnt(5)
  buffer_load_dwordx4 v19, s[40:43], s56 offen offset:0 nt lds
  s_add_u32 m0, s55, 28672
  s_xor_b32 s56, s88, 7512064
  s_waitcnt vmcnt(5)
  buffer_load_dwordx4 v16, s[40:43], s56 offen offset:0 nt lds
  s_add_u32 m0, s55, 29696
  s_xor_b32 s56, s88, 7516160
  s_waitcnt vmcnt(5)
  buffer_load_dwordx4 v17, s[40:43], s56 offen offset:0 nt lds
  s_add_u32 m0, s55, 30720
  s_xor_b32 s56, s88, 7514112
  s_waitcnt vmcnt(5)
  buffer_load_dwordx4 v18, s[40:43], s56 offen offset:0 nt lds
  s_add_u32 m0, s55, 31744
  s_xor_b32 s56, s88, 7518208
  s_waitcnt vmcnt(5)
  buffer_load_dwordx4 v19, s[40:43], s56 offen offset:0 nt lds
  v_mov_b32 v20, 152960
  ds_write_b32 v20, v20 offset:4
  v_and_b32 v8, 7, v1
  v_mul_u32_u24 v14, 272, v8
  v_lshl_add_u32 v14, v2, 4, v14
  v_add_u32 v14, 150016, v14
  v_cmp_gt_u32 vcc, 8, v3
  s_nop 1
  v_cndmask_b32 v15, 0, -1, vcc
  v_not_b32 v16, v15
  v_lshlrev_b32 v17, 3, v8
  v_add_u32 v17, 152192, v17
  s_xor_b32 s56, s88, 0
  s_waitcnt vmcnt(5)
  buffer_load_dwordx4 v[128:131], v9, s[44:47], s56 offen offset:0 nt
  s_xor_b32 s56, s88, 4096
  s_waitcnt vmcnt(5)
  buffer_load_dwordx4 v[132:135], v9, s[44:47], s56 offen offset:0 nt
  s_xor_b32 s56, s88, 2048
  s_waitcnt vmcnt(5)
  buffer_load_dwordx4 v[136:139], v9, s[44:47], s56 offen offset:0 nt
  s_xor_b32 s56, s88, 6144
  s_waitcnt vmcnt(5)
  buffer_load_dwordx4 v[140:143], v9, s[44:47], s56 offen offset:0 nt
  s_xor_b32 s56, s88, 2260992
  s_waitcnt vmcnt(5)
  buffer_load_dwordx4 v[144:147], v9, s[44:47], s56 offen offset:0 nt
  s_xor_b32 s56, s88, 2265088
  s_waitcnt vmcnt(5)
  buffer_load_dwordx4 v[148:151], v9, s[44:47], s56 offen offset:0 nt
  s_xor_b32 s56, s88, 2263040
  s_waitcnt vmcnt(5)
  buffer_load_dwordx4 v[152:155], v9, s[44:47], s56 offen offset:0 nt
  s_xor_b32 s56, s88, 2267136
  s_waitcnt vmcnt(5)
  buffer_load_dwordx4 v[156:159], v9, s[44:47], s56 offen offset:0 nt
  s_xor_b32 s56, s88, 1056768
  s_waitcnt vmcnt(5)
  buffer_load_dwordx4 v[160:163], v9, s[44:47], s56 offen offset:0 nt
  s_xor_b32 s56, s88, 1060864
  s_waitcnt vmcnt(5)
  buffer_load_dwordx4 v[164:167], v9, s[44:47], s56 offen offset:0 nt
  s_xor_b32 s56, s88, 1058816
  s_waitcnt vmcnt(6)
  buffer_load_dwordx4 v[168:171], v9, s[44:47], s56 offen offset:0 nt
  s_xor_b32 s56, s88, 1062912
  s_waitcnt vmcnt(6)
  buffer_load_dwordx4 v[172:175], v9, s[44:47], s56 offen offset:0 nt
  s_xor_b32 s56, s88, 3317760
  s_waitcnt vmcnt(6)
  buffer_load_dwordx4 v[176:179], v9, s[44:47], s56 offen offset:0 nt
  s_xor_b32 s56, s88, 3321856
  s_waitcnt vmcnt(6)
  buffer_load_dwordx4 v[180:183], v9, s[44:47], s56 offen offset:0 nt
  s_waitcnt vmcnt(14)
L_qwL:
  ds_read_b128 v[64:67], v14 offset:0
  ds_read_b128 v[68:71], v14 offset:64
  ds_read_b128 v[72:75], v14 offset:128
  ds_read_b128 v[76:79], v14 offset:192
  s_waitcnt lgkmcnt(0)
  v_max3_u32 v18, v64, v65, v66
  v_max3_u32 v18, v18, v67, v68
  v_max3_u32 v18, v18, v69, v70
  v_max3_u32 v18, v18, v71, v72
  v_max3_u32 v18, v18, v73, v74
  v_max3_u32 v18, v18, v75, v76
  v_max3_u32 v18, v18, v77, v78
  v_max_u32 v18, v18, v79
  v_cmp_eq_u32 vcc, -1, v18
  s_nop 0
  s_cbranch_vccz L_qwL_ok
  s_sleep 1
  s_sub_u32 s62, s62, 1
  s_cmp_gt_i32 s62, 0
  s_cbranch_scc1 L_qwL
L_qwL_ok:
  ds_read_b128 v[96:99], v10 offset:0
  ds_read_b128 v[100:103], v11 offset:0
  ds_read_b128 v[104:107], v12 offset:0
  ds_read_b128 v[108:111], v13 offset:0
  ds_read_b128 v[112:115], v10 offset:8192
  ds_read_b128 v[116:119], v11 offset:8192
  ds_read_b128 v[120:123], v12 offset:8192
  ds_read_b128 v[124:127], v13 offset:8192
  s_xor_b32 s56, s88, 3319808
  s_waitcnt vmcnt(6)
  buffer_load_dwordx4 v[184:187], v9, s[44:47], s56 offen offset:0 nt
  v_and_b32 v80, v16, v64
  v_and_b32 v64, v15, v64
  v_and_b32 v81, v16, v65
  v_and_b32 v65, v15, v65
  v_and_b32 v82, v16, v66
  v_and_b32 v66, v15, v66
  v_and_b32 v83, v16, v67
  v_and_b32 v67, v15, v67
  v_and_b32 v84, v16, v68
  v_and_b32 v68, v15, v68
  v_and_b32 v85, v16, v69
  v_and_b32 v69, v15, v69
  v_and_b32 v86, v16, v70
  v_and_b32 v70, v15, v70
  v_and_b32 v87, v16, v71
  v_and_b32 v71, v15, v71
  v_and_b32 v88, v16, v72
  v_and_b32 v72, v15, v72
  v_and_b32 v89, v16, v73
  v_and_b32 v73, v15, v73
  v_and_b32 v90, v16, v74
  v_and_b32 v74, v15, v74
  v_and_b32 v91, v16, v75
  v_and_b32 v75, v15, v75
  v_and_b32 v92, v16, v76
  v_and_b32 v76, v15, v76
  v_and_b32 v93, v16, v77
  v_and_b32 v77, v15, v77
  v_and_b32 v94, v16, v78
  v_and_b32 v78, v15, v78
  v_and_b32 v95, v16, v79
  v_and_b32 v79, v15, v79
  s_waitcnt lgkmcnt(4)
  v_mfma_f32_16x16x32_bf16 v[32:35], v[96:99], v[64:67], 0
  v_mfma_f32_16x16x32_bf16 v[32:35], v[100:103], v[68:71], v[32:35]
  v_mfma_f32_16x16x32_bf16 v[32:35], v[104:107], v[72:75], v[32:35]
  v_mfma_f32_16x16x32_bf16 v[32:35], v[108:111], v[76:79], v[32:35]
  ds_read_b128 v[96:99], v10 offset:4096
  ds_read_b128 v[100:103], v11 offset:4096
  ds_read_b128 v[104:107], v12 offset:4096
  ds_read_b128 v[108:111], v13 offset:4096
  s_waitcnt lgkmcnt(4)
  v_mfma_f32_16x16x32_bf16 v[32:35], v[112:115], v[80:83], v[32:35]
  v_mfma_f32_16x16x32_bf16 v[32:35], v[116:119], v[84:87], v[32:35]
  v_mfma_f32_16x16x32_bf16 v[32:35], v[120:123], v[88:91], v[32:35]
  v_mfma_f32_16x16x32_bf16 v[32:35], v[124:127], v[92:95], v[32:35]
  ds_read_b128 v[112:115], v10 offset:12288
  ds_read_b128 v[116:119], v11 offset:12288
  ds_read_b128 v[120:123], v12 offset:12288
  ds_read_b128 v[124:127], v13 offset:12288
  s_xor_b32 s56, s88, 3323904
  s_waitcnt vmcnt(6)
  buffer_load_dwordx4 v[188:191], v9, s[44:47], s56 offen offset:0 nt
  s_waitcnt lgkmcnt(4)
  v_mfma_f32_16x16x32_bf16 v[36:39], v[96:99], v[64:67], 0
  v_mfma_f32_16x16x32_bf16 v[36:39], v[100:103], v[68:71], v[36:39]
  v_mfma_f32_16x16x32_bf16 v[36:39], v[104:107], v[72:75], v[36:39]
  v_mfma_f32_16x16x32_bf16 v[36:39], v[108:111], v[76:79], v[36:39]
  ds_read_b128 v[96:99], v10 offset:16384
  ds_read_b128 v[100:103], v11 offset:16384
  ds_read_b128 v[104:107], v12 offset:16384
  ds_read_b128 v[108:111], v13 offset:16384
  s_waitcnt lgkmcnt(4)
  v_mfma_f32_16x16x32_bf16 v[36:39], v[112:115], v[80:83], v[36:39]
  v_mfma_f32_16x16x32_bf16 v[36:39], v[116:119], v[84:87], v[36:39]
  v_mfma_f32_16x16x32_bf16 v[36:39], v[120:123], v[88:91], v[36:39]
  v_mfma_f32_16x16x32_bf16 v[36:39], v[124:127], v[92:95], v[36:39]
  ds_read_b128 v[112:115], v10 offset:24576
  ds_read_b128 v[116:119], v11 offset:24576
  ds_read_b128 v[120:123], v12 offset:24576
  ds_read_b128 v[124:127], v13 offset:24576
  s_waitcnt lgkmcnt(4)
  v_mfma_f32_16x16x32_bf16 v[40:43], v[96:99], v[64:67], 0
  v_mfma_f32_16x16x32_bf16 v[40:43], v[100:103], v[68:71], v[40:43]
  v_mfma_f32_16x16x32_bf16 v[40:43], v[104:107], v[72:75], v[40:43]
  v_mfma_f32_16x16x32_bf16 v[40:43], v[108:111], v[76:79], v[40:43]
  ds_read_b128 v[96:99], v10 offset:20480
  ds_read_b128 v[100:103], v11 offset:20480
  ds_read_b128 v[104:107], v12 offset:20480
  ds_read_b128 v[108:111], v13 offset:20480
  s_xor_b32 s56, s88, 4194304
  s_waitcnt vmcnt(6)
  buffer_load_dwordx4 v[192:195], v9, s[44:47], s56 offen offset:0 nt
  s_waitcnt lgkmcnt(4)
  v_mfma_f32_16x16x32_bf16 v[40:43], v[112:115], v[80:83], v[40:43]
  v_mfma_f32_16x16x32_bf16 v[40:43], v[116:119], v[84:87], v[40:43]
  v_mfma_f32_16x16x32_bf16 v[40:43], v[120:123], v[88:91], v[40:43]
  v_mfma_f32_16x16x32_bf16 v[40:43], v[124:127], v[92:95], v[40:43]
  ds_read_b128 v[112:115], v10 offset:28672
  ds_read_b128 v[116:119], v11 offset:28672
  ds_read_b128 v[120:123], v12 offset:28672
  ds_read_b128 v[124:127], v13 offset:28672
  s_waitcnt lgkmcnt(4)
  v_mfma_f32_16x16x32_bf16 v[44:47], v[96:99], v[64:67], 0
  v_mfma_f32_16x16x32_bf16 v[44:47], v[100:103], v[68:71], v[44:47]
  v_mfma_f32_16x16x32_bf16 v[44:47], v[104:107], v[72:75], v[44:47]
  v_mfma_f32_16x16x32_bf16 v[44:47], v[108:111], v[76:79], v[44:47]
  s_waitcnt lgkmcnt(0)
  v_mfma_f32_16x16x32_bf16 v[44:47], v[112:115], v[80:83], v[44:47]
  v_mfma_f32_16x16x32_bf16 v[44:47], v[116:119], v[84:87], v[44:47]
  v_mfma_f32_16x16x32_bf16 v[44:47], v[120:123], v[88:91], v[44:47]
  v_mfma_f32_16x16x32_bf16 v[44:47], v[124:127], v[92:95], v[44:47]
  s_xor_b32 s56, s88, 4198400
  s_waitcnt vmcnt(6)
  buffer_load_dwordx4 v[196:199], v9, s[44:47], s56 offen offset:0 nt
  s_mov_b32 s57, 1035273459
  s_mov_b32 s58, 1069066811
  v_cvt_pk_bf16_f32 v32, v32, v33
  v_and_b32 v33, 0xffff0000, v32
  v_lshlrev_b32 v32, 16, v32
  v_mul_f32 v32, s57, v32
  v_mul_f32 v33, s57, v33
  v_cvt_pk_bf16_f32 v32, v32, v33
  v_and_b32 v33, 0xffff0000, v32
  v_lshlrev_b32 v32, 16, v32
  v_cvt_pk_bf16_f32 v34, v34, v35
  v_and_b32 v35, 0xffff0000, v34
  v_lshlrev_b32 v34, 16, v34
  v_mul_f32 v34, s57, v34
  v_mul_f32 v35, s57, v35
  v_cvt_pk_bf16_f32 v34, v34, v35
  v_and_b32 v35, 0xffff0000, v34
  v_lshlrev_b32 v34, 16, v34
  v_cvt_pk_bf16_f32 v36, v36, v37
  v_and_b32 v37, 0xffff0000, v36
  v_lshlrev_b32 v36, 16, v36
  v_mul_f32 v36, s57, v36
  v_mul_f32 v37, s57, v37
  v_cvt_pk_bf16_f32 v36, v36, v37
  v_and_b32 v37, 0xffff0000, v36
  v_lshlrev_b32 v36, 16, v36
  v_cvt_pk_bf16_f32 v38, v38, v39
  v_and_b32 v39, 0xffff0000, v38
  v_lshlrev_b32 v38, 16, v38
  v_mul_f32 v38, s57, v38
  v_mul_f32 v39, s57, v39
  v_cvt_pk_bf16_f32 v38, v38, v39
  v_and_b32 v39, 0xffff0000, v38
  v_lshlrev_b32 v38, 16, v38
  v_cvt_pk_bf16_f32 v40, v40, v41
  v_and_b32 v41, 0xffff0000, v40
  v_lshlrev_b32 v40, 16, v40
  v_mul_f32 v40, s57, v40
  v_mul_f32 v41, s57, v41
  v_cvt_pk_bf16_f32 v40, v40, v41
  v_and_b32 v41, 0xffff0000, v40
  v_lshlrev_b32 v40, 16, v40
  v_cvt_pk_bf16_f32 v42, v42, v43
  v_and_b32 v43, 0xffff0000, v42
  v_lshlrev_b32 v42, 16, v42
  v_mul_f32 v42, s57, v42
  v_mul_f32 v43, s57, v43
  v_cvt_pk_bf16_f32 v42, v42, v43
  v_and_b32 v43, 0xffff0000, v42
  v_lshlrev_b32 v42, 16, v42
  v_cvt_pk_bf16_f32 v44, v44, v45
  v_and_b32 v45, 0xffff0000, v44
  v_lshlrev_b32 v44, 16, v44
  v_mul_f32 v44, s57, v44
  v_mul_f32 v45, s57, v45
  v_cvt_pk_bf16_f32 v44, v44, v45
  v_and_b32 v45, 0xffff0000, v44
  v_lshlrev_b32 v44, 16, v44
  v_cvt_pk_bf16_f32 v46, v46, v47
  v_and_b32 v47, 0xffff0000, v46
  v_lshlrev_b32 v46, 16, v46
  v_mul_f32 v46, s57, v46
  v_mul_f32 v47, s57, v47
  v_cvt_pk_bf16_f32 v46, v46, v47
  v_and_b32 v47, 0xffff0000, v46
  v_lshlrev_b32 v46, 16, v46
  s_xor_b32 s56, s88, 4196352
  s_waitcnt vmcnt(6)
  buffer_load_dwordx4 v[200:203], v9, s[44:47], s56 offen offset:0 nt
  v_max3_f32 v18, v32, v33, v34
  v_max3_f32 v18, v18, v35, v36
  v_max3_f32 v18, v18, v37, v38
  v_max3_f32 v18, v18, v39, v40
  v_max3_f32 v18, v18, v41, v42
  v_max3_f32 v18, v18, v43, v44
  v_max3_f32 v18, v18, v45, v46
  v_max_f32 v18, v18, v47
  s_nop 1
  v_max_f32_dpp v18, v18, v18 row_ror:8 row_mask:0xf bank_mask:0xf
  v_mov_b32 v20, v18
  s_nop 1
  v_permlane16_swap_b32 v20, v18
  v_max_f32 v18, v18, v20
  v_mov_b32 v20, v18
  s_nop 1
  v_permlane32_swap_b32 v20, v18
  v_max_f32 v18, v18, v20
  v_sub_f32 v32, v32, v18
  v_mul_f32 v32, s58, v32
  v_sub_f32 v33, v33, v18
  v_mul_f32 v33, s58, v33
  v_sub_f32 v34, v34, v18
  v_mul_f32 v34, s58, v34
  v_sub_f32 v35, v35, v18
  v_mul_f32 v35, s58, v35
  v_sub_f32 v36, v36, v18
  v_mul_f32 v36, s58, v36
  v_sub_f32 v37, v37, v18
  v_mul_f32 v37, s58, v37
  v_sub_f32 v38, v38, v18
  v_mul_f32 v38, s58, v38
  v_sub_f32 v39, v39, v18
  v_mul_f32 v39, s58, v39
  v_sub_f32 v40, v40, v18
  v_mul_f32 v40, s58, v40
  v_sub_f32 v41, v41, v18
  v_mul_f32 v41, s58, v41
  v_sub_f32 v42, v42, v18
  v_mul_f32 v42, s58, v42
  v_sub_f32 v43, v43, v18
  v_mul_f32 v43, s58, v43
  v_sub_f32 v44, v44, v18
  v_mul_f32 v44, s58, v44
  v_sub_f32 v45, v45, v18
  v_mul_f32 v45, s58, v45
  v_sub_f32 v46, v46, v18
  v_mul_f32 v46, s58, v46
  v_sub_f32 v47, v47, v18
  v_mul_f32 v47, s58, v47
  s_xor_b32 s56, s88, 4200448
  s_waitcnt vmcnt(6)
  buffer_load_dwordx4 v[204:207], v9, s[44:47], s56 offen offset:0 nt
  v_exp_f32 v32, v32
  v_exp_f32 v33, v33
  v_exp_f32 v34, v34
  v_exp_f32 v35, v35
  v_exp_f32 v36, v36
  v_exp_f32 v37, v37
  v_exp_f32 v38, v38
  v_exp_f32 v39, v39
  v_exp_f32 v40, v40
  v_exp_f32 v41, v41
  v_exp_f32 v42, v42
  v_exp_f32 v43, v43
  v_exp_f32 v44, v44
  v_exp_f32 v45, v45
  v_exp_f32 v46, v46
  v_exp_f32 v47, v47
  v_add_f32 v19, v32, v33
  v_add_f32 v19, v19, v34
  v_add_f32 v19, v19, v35
  v_add_f32 v19, v19, v36
  v_add_f32 v19, v19, v37
  v_add_f32 v19, v19, v38
  v_add_f32 v19, v19, v39
  v_add_f32 v19, v19, v40
  v_add_f32 v19, v19, v41
  v_add_f32 v19, v19, v42
  v_add_f32 v19, v19, v43
  v_add_f32 v19, v19, v44
  v_add_f32 v19, v19, v45
  v_add_f32 v19, v19, v46
  v_add_f32 v19, v19, v47
  s_nop 1
  v_add_f32_dpp v19, v19, v19 row_ror:8 row_mask:0xf bank_mask:0xf
  v_mov_b32 v20, v19
  s_nop 1
  v_permlane16_swap_b32 v20, v19
  v_add_f32 v19, v19, v20
  v_mov_b32 v20, v19
  s_nop 1
  v_permlane32_swap_b32 v20, v19
  v_add_f32 v19, v19, v20
  s_lshl_b32 s59, s63, 6
  v_add_u32 v20, s59, v17
  ds_write_b64 v20, v[18:19]
  s_xor_b32 s56, s88, 6455296
  s_waitcnt vmcnt(6)
  buffer_load_dwordx4 v[208:211], v9, s[44:47], s56 offen offset:0 nt
  v_cvt_pk_bf16_f32 v24, v32, v33
  v_cvt_pk_bf16_f32 v25, v34, v35
  v_cvt_pk_bf16_f32 v26, v36, v37
  v_cvt_pk_bf16_f32 v27, v38, v39
  v_cvt_pk_bf16_f32 v28, v40, v41
  v_cvt_pk_bf16_f32 v29, v42, v43
  v_cvt_pk_bf16_f32 v30, v44, v45
  v_cvt_pk_bf16_f32 v31, v46, v47
  v_and_b32 v64, v15, v24
  v_mov_b32_dpp v68, v24 row_shr:8 row_mask:0xf bank_mask:0xf bound_ctrl:1
  v_mov_b32_dpp v72, v24 row_shl:8 row_mask:0xf bank_mask:0xf bound_ctrl:1
  v_and_b32 v76, v16, v24
  v_and_b32 v65, v15, v25
  v_mov_b32_dpp v69, v25 row_shr:8 row_mask:0xf bank_mask:0xf bound_ctrl:1
  v_mov_b32_dpp v73, v25 row_shl:8 row_mask:0xf bank_mask:0xf bound_ctrl:1
  v_and_b32 v77, v16, v25
  v_and_b32 v66, v15, v26
  v_mov_b32_dpp v70, v26 row_shr:8 row_mask:0xf bank_mask:0xf bound_ctrl:1
  v_mov_b32_dpp v74, v26 row_shl:8 row_mask:0xf bank_mask:0xf bound_ctrl:1
  v_and_b32 v78, v16, v26
  v_and_b32 v67, v15, v27
  v_mov_b32_dpp v71, v27 row_shr:8 row_mask:0xf bank_mask:0xf bound_ctrl:1
  v_mov_b32_dpp v75, v27 row_shl:8 row_mask:0xf bank_mask:0xf bound_ctrl:1
  v_and_b32 v79, v16, v27
  v_and_b32 v80, v15, v28
  v_mov_b32_dpp v84, v28 row_shr:8 row_mask:0xf bank_mask:0xf bound_ctrl:1
  v_mov_b32_dpp v88, v28 row_shl:8 row_mask:0xf bank_mask:0xf bound_ctrl:1
  v_and_b32 v92, v16, v28
  v_and_b32 v81, v15, v29
  v_mov_b32_dpp v85, v29 row_shr:8 row_mask:0xf bank_mask:0xf bound_ctrl:1
  v_mov_b32_dpp v89, v29 row_shl:8 row_mask:0xf bank_mask:0xf bound_ctrl:1
  v_and_b32 v93, v16, v29
  v_and_b32 v82, v15, v30
  v_mov_b32_dpp v86, v30 row_shr:8 row_mask:0xf bank_mask:0xf bound_ctrl:1
  v_mov_b32_dpp v90, v30 row_shl:8 row_mask:0xf bank_mask:0xf bound_ctrl:1
  v_and_b32 v94, v16, v30
  v_and_b32 v83, v15, v31
  v_mov_b32_dpp v87, v31 row_shr:8 row_mask:0xf bank_mask:0xf bound_ctrl:1
  v_mov_b32_dpp v91, v31 row_shl:8 row_mask:0xf bank_mask:0xf bound_ctrl:1
  v_and_b32 v95, v16, v31
  s_xor_b32 s56, s88, 6459392
  s_waitcnt vmcnt(6)
  buffer_load_dwordx4 v[212:215], v9, s[44:47], s56 offen offset:0 nt
  s_mov_b32 s32, s12
  s_mov_b32 s33, s13
  s_mov_b32 s34, 8388608
  s_mov_b32 s35, 0x20000
  s_mov_b32 s36, s20
  s_mov_b32 s37, s21
  s_mov_b32 s38, 7340032
  s_mov_b32 s39, 0x20000
  s_lshr_b32 s52, s2, 3
  s_and_b32 s59, s63, 1
  s_lshl1_add_u32 s52, s52, s59
  s_and_b32 s53, s2, 7
  s_lshr_b32 s57, s63, 1
  s_lshl1_add_u32 s53, s53, s57
  s_lshl_b32 s57, s53, 7
  s_mul_i32 s48, s52, 114688
  s_add_u32 s48, s48, s57
  s_lshl_b32 s49, s52, 17
  s_add_u32 s49, s49, s57
  s_and_b32 s50, s2, 7
  s_lshl_b32 s50, s50, 6
  s_add_u32 s50, s50, s52
  s_and_b32 s51, s53, 1
  s_lshl1_add_u32 s50, s50, s51
  s_lshl_b32 s50, s50, 9
  s_add_u32 s50, s50, 786432
  v_lshrrev_b32 v20, 3, v1
  v_lshlrev_b32 v21, 4, v8
  v_mul_u32_u24 v6, 14336, v20
  v_add_u32 v6, v6, v21
  v_and_b32 v7, 3, v20
  v_lshl_add_u32 v7, v7, 12, v21
  v_and_b32 v20, 4, v20
  v_lshl_add_u32 v7, v20, 14, v7
  v_and_b32 v10, 6, v1
  v_lshlrev_b32 v10, 6, v10
  v_and_b32 v20, 8, v1
  v_lshl_add_u32 v10, v20, 2, v10
  v_and_b32 v21, 1, v1
  v_lshl_add_u32 v10, v21, 6, v10
  v_lshl_add_u32 v10, v2, 4, v10
  v_mov_b32 v21, 1073741824
  v_cmp_gt_u32 vcc, 32, v1
  s_nop 1
  v_cndmask_b32 v10, v21, v10, vcc
  v_and_b32 v21, 1, v1
  v_lshl_add_u32 v11, v2, 1, v21
  v_lshlrev_b32 v11, 4, v11
  s_lshl_b32 s59, s59, 7
  s_add_u32 s59, s59, 152448
  v_add_u32 v11, s59, v11
  v_mul_u32_u24 v5, 528, v8
  v_lshl_add_u32 v5, v2, 7, v5
  v_lshl_add_u32 v5, v20, 3, v5
  s_mul_i32 s57, s63, 4224
  s_add_u32 s57, s57, 131072
  v_add_u32 v5, s57, v5
  s_lshl_b32 s57, s63, 2
  s_add_u32 s57, s57, 152976
  v_mov_b32 v13, s57
  v_mov_b32 v12, 0xfffff000
  v_mov_b32 v20, 152960
  ds_read_b32 v20, v20 offset:12
  s_waitcnt lgkmcnt(0)
  v_readfirstlane_b32 s96, v20
  s_nop 0
  s_bfe_u32 s97, s96, 786432
  s_bfe_u32 s98, s96, 786444
  s_bfe_u32 s99, s96, 786452
  s_bfe_u32 s100, s96, 786438
  s_xor_b32 s56, s88, 6457344
  s_waitcnt vmcnt(6)
  buffer_load_dwordx4 v[216:219], v9, s[44:47], s56 offen offset:0 nt
  v_perm_b32 v96, v132, v128, s60
  v_perm_b32 v100, v132, v128, s61
  v_perm_b32 v104, v133, v129, s60
  v_perm_b32 v108, v133, v129, s61
  v_perm_b32 v112, v134, v130, s60
  v_perm_b32 v116, v134, v130, s61
  v_perm_b32 v120, v135, v131, s60
  v_perm_b32 v124, v135, v131, s61
  v_perm_b32 v97, v140, v136, s60
  v_perm_b32 v101, v140, v136, s61
  v_perm_b32 v105, v141, v137, s60
  v_perm_b32 v109, v141, v137, s61
  v_perm_b32 v113, v142, v138, s60
  v_perm_b32 v117, v142, v138, s61
  v_perm_b32 v121, v143, v139, s60
  v_perm_b32 v125, v143, v139, s61
  s_xor_b32 s56, s88, 6461440
  s_waitcnt vmcnt(6)
  buffer_load_dwordx4 v[220:223], v9, s[44:47], s56 offen offset:0 nt
  v_perm_b32 v98, v148, v144, s60
  v_perm_b32 v102, v148, v144, s61
  v_perm_b32 v106, v149, v145, s60
  v_perm_b32 v110, v149, v145, s61
  v_perm_b32 v114, v150, v146, s60
  v_perm_b32 v118, v150, v146, s61
  v_perm_b32 v122, v151, v147, s60
  v_perm_b32 v126, v151, v147, s61
  v_perm_b32 v99, v156, v152, s60
  v_perm_b32 v103, v156, v152, s61
  v_perm_b32 v107, v157, v153, s60
  v_perm_b32 v111, v157, v153, s61
  v_perm_b32 v115, v158, v154, s60
  v_perm_b32 v119, v158, v154, s61
  v_perm_b32 v123, v159, v155, s60
  v_perm_b32 v127, v159, v155, s61
  v_mfma_f32_16x16x32_bf16 v[48:51], v[96:99], v[64:67], 0
  v_mfma_f32_16x16x32_bf16 v[52:55], v[100:103], v[64:67], 0
  v_mfma_f32_16x16x32_bf16 v[56:59], v[104:107], v[64:67], 0
  v_mfma_f32_16x16x32_bf16 v[60:63], v[108:111], v[64:67], 0
  v_mfma_f32_16x16x32_bf16 v[48:51], v[112:115], v[68:71], v[48:51]
  v_mfma_f32_16x16x32_bf16 v[52:55], v[116:119], v[68:71], v[52:55]
  v_mfma_f32_16x16x32_bf16 v[56:59], v[120:123], v[68:71], v[56:59]
  v_mfma_f32_16x16x32_bf16 v[60:63], v[124:127], v[68:71], v[60:63]
  v_mov_b32 v156, 0
  v_mov_b32 v157, 0
  v_mov_b32 v158, 0
  v_mov_b32 v159, 0
  s_xor_b32 s56, s88, 5251072
  s_waitcnt vmcnt(6)
  buffer_load_dwordx4 v[224:227], v9, s[44:47], s56 offen offset:0 nt
  v_perm_b32 v96, v164, v160, s60
  v_perm_b32 v100, v164, v160, s61
  v_perm_b32 v104, v165, v161, s60
  v_perm_b32 v108, v165, v161, s61
  v_perm_b32 v112, v166, v162, s60
  v_perm_b32 v116, v166, v162, s61
  v_perm_b32 v120, v167, v163, s60
  v_perm_b32 v124, v167, v163, s61
  v_perm_b32 v97, v172, v168, s60
  v_perm_b32 v101, v172, v168, s61
  v_perm_b32 v105, v173, v169, s60
  v_perm_b32 v109, v173, v169, s61
  v_perm_b32 v113, v174, v170, s60
  v_perm_b32 v117, v174, v170, s61
  v_perm_b32 v121, v175, v171, s60
  v_perm_b32 v125, v175, v171, s61
  s_xor_b32 s56, s88, 5255168
  s_waitcnt vmcnt(6)
  buffer_load_dwordx4 v[228:231], v9, s[44:47], s56 offen offset:0 nt
  v_perm_b32 v98, v180, v176, s60
  v_perm_b32 v102, v180, v176, s61
  v_perm_b32 v106, v181, v177, s60
  v_perm_b32 v110, v181, v177, s61
  v_perm_b32 v114, v182, v178, s60
  v_perm_b32 v118, v182, v178, s61
  v_perm_b32 v122, v183, v179, s60
  v_perm_b32 v126, v183, v179, s61
  v_perm_b32 v99, v188, v184, s60
  v_perm_b32 v103, v188, v184, s61
  v_perm_b32 v107, v189, v185, s60
  v_perm_b32 v111, v189, v185, s61
  v_perm_b32 v115, v190, v186, s60
  v_perm_b32 v119, v190, v186, s61
  v_perm_b32 v123, v191, v187, s60
  v_perm_b32 v127, v191, v187, s61
  v_mfma_f32_16x16x32_bf16 v[48:51], v[96:99], v[72:75], v[48:51]
  v_mfma_f32_16x16x32_bf16 v[52:55], v[100:103], v[72:75], v[52:55]
  v_mfma_f32_16x16x32_bf16 v[56:59], v[104:107], v[72:75], v[56:59]
  v_mfma_f32_16x16x32_bf16 v[60:63], v[108:111], v[72:75], v[60:63]
  v_mfma_f32_16x16x32_bf16 v[48:51], v[112:115], v[76:79], v[48:51]
  v_mfma_f32_16x16x32_bf16 v[52:55], v[116:119], v[76:79], v[52:55]
  v_mfma_f32_16x16x32_bf16 v[56:59], v[120:123], v[76:79], v[56:59]
  v_mfma_f32_16x16x32_bf16 v[60:63], v[124:127], v[76:79], v[60:63]
  s_xor_b32 s56, s88, 5253120
  s_waitcnt vmcnt(6)
  buffer_load_dwordx4 v[232:235], v9, s[44:47], s56 offen offset:0 nt
  v_perm_b32 v96, v196, v192, s60
  v_perm_b32 v100, v196, v192, s61
  v_perm_b32 v104, v197, v193, s60
  v_perm_b32 v108, v197, v193, s61
  v_perm_b32 v112, v198, v194, s60
  v_perm_b32 v116, v198, v194, s61
  v_perm_b32 v120, v199, v195, s60
  v_perm_b32 v124, v199, v195, s61
  v_perm_b32 v97, v204, v200, s60
  v_perm_b32 v101, v204, v200, s61
  v_perm_b32 v105, v205, v201, s60
  v_perm_b32 v109, v205, v201, s61
  v_perm_b32 v113, v206, v202, s60
  v_perm_b32 v117, v206, v202, s61
  v_perm_b32 v121, v207, v203, s60
  v_perm_b32 v125, v207, v203, s61
  s_xor_b32 s56, s88, 5257216
  s_waitcnt vmcnt(6)
  buffer_load_dwordx4 v[236:239], v9, s[44:47], s56 offen offset:0 nt
  v_lshrrev_b32 v21, 5, v1
  v_add_lshl_u32 v14, v21, v1, 4
  s_mul_i32 s57, s63, 1056
  s_add_u32 s57, s57, 131072
  v_add_u32 v14, s57, v14
  v_mul_u32_u24 v15, 4224, v2
  v_add_u32 v15, 135276, v15
  v_lshlrev_b32 v16, 10, v2
  v_lshl_add_u32 v16, v3, 3, v16
  s_and_b32 s57, s2, 7
  s_bfe_u32 s59, s2, 0x20003
  s_lshl2_add_u32 s57, s57, s59
  s_lshl2_add_u32 s57, s57, s63
  s_lshl_b32 s57, s57, 5
  s_lshr_b32 s59, s2, 5
  s_add_u32 s57, s57, s59
  s_lshl_b32 s93, s57, 7
  s_add_u32 s93, s93, 786432
  v_mov_b32 v22, s96
  v_lshlrev_b32 v23, 1, v3
  v_alignbit_b32 v22, v22, v22, v23
  v_and_b32 v18, 0x10001, v22
  v_alignbit_b32 v19, v22, v22, 1
  v_and_b32 v19, 0x10001, v19
  s_lshl_b32 s57, s63, 4
  s_add_u32 s57, s57, 152192
  v_lshl_add_u32 v21, v21, 3, s57
  v_mov_b32 v17, 0xfffefffe
  v_mov_b32 v22, 152960
L_mlfL:
  ds_read_b32 v36, v21 offset:0
  ds_read_b32 v38, v21 offset:64
  ds_read_b32 v40, v21 offset:128
  ds_read_b32 v42, v21 offset:192
  ds_read_b32 v37, v22 offset:8
  s_waitcnt lgkmcnt(0)
  v_max3_u32 v20, v36, v37, v38
  v_max3_u32 v20, v20, v40, v42
  v_cmp_eq_u32 vcc, -1, v20
  s_nop 0
  s_cbranch_vccz L_mlfL_ok
  s_sub_u32 s62, s62, 1
  s_cmp_gt_i32 s62, 0
  s_cbranch_scc1 L_mlfL
L_mlfL_ok:
  v_readfirstlane_b32 s92, v37
  v_max3_f32 v20, v36, v38, v40
  v_max_f32 v20, v20, v42
  v_mul_f32 v20, s58, v20
  v_ceil_f32 v20, v20
  v_fma_f32 v36, v36, s58, -v20
  v_exp_f32 v36, v36
  s_nop 0
  v_mov_b32 v37, v36
  v_fma_f32 v38, v38, s58, -v20
  v_exp_f32 v38, v38
  s_nop 0
  v_mov_b32 v39, v38
  v_fma_f32 v40, v40, s58, -v20
  v_exp_f32 v40, v40
  s_nop 0
  v_mov_b32 v41, v40
  v_fma_f32 v42, v42, s58, -v20
  v_exp_f32 v42, v42
  s_nop 0
  v_mov_b32 v43, v42
  s_xor_b32 s56, s88, 7512064
  s_waitcnt vmcnt(6)
  buffer_load_dwordx4 v[240:243], v9, s[44:47], s56 offen offset:0 nt
  v_perm_b32 v98, v212, v208, s60
  v_perm_b32 v102, v212, v208, s61
  v_perm_b32 v106, v213, v209, s60
  v_perm_b32 v110, v213, v209, s61
  v_perm_b32 v114, v214, v210, s60
  v_perm_b32 v118, v214, v210, s61
  v_perm_b32 v122, v215, v211, s60
  v_perm_b32 v126, v215, v211, s61
  s_xor_b32 s56, s88, 7516160
  s_waitcnt vmcnt(6)
  buffer_load_dwordx4 v[244:247], v9, s[44:47], s56 offen offset:0 nt
  s_xor_b32 s56, s88, 7514112
  s_waitcnt vmcnt(6)
  buffer_load_dwordx4 v[248:251], v9, s[44:47], s56 offen offset:0 nt
  v_perm_b32 v99, v220, v216, s60
  v_perm_b32 v103, v220, v216, s61
  v_perm_b32 v107, v221, v217, s60
  v_perm_b32 v111, v221, v217, s61
  v_perm_b32 v115, v222, v218, s60
  v_perm_b32 v119, v222, v218, s61
  v_perm_b32 v123, v223, v219, s60
  v_perm_b32 v127, v223, v219, s61
  v_mfma_f32_16x16x32_bf16 v[48:51], v[96:99], v[80:83], v[48:51]
  v_mfma_f32_16x16x32_bf16 v[52:55], v[100:103], v[80:83], v[52:55]
  v_mfma_f32_16x16x32_bf16 v[56:59], v[104:107], v[80:83], v[56:59]
  v_mfma_f32_16x16x32_bf16 v[60:63], v[108:111], v[80:83], v[60:63]
  v_mfma_f32_16x16x32_bf16 v[48:51], v[112:115], v[84:87], v[48:51]
  v_mfma_f32_16x16x32_bf16 v[52:55], v[116:119], v[84:87], v[52:55]
  v_mfma_f32_16x16x32_bf16 v[56:59], v[120:123], v[84:87], v[56:59]
  v_mfma_f32_16x16x32_bf16 v[60:63], v[124:127], v[84:87], v[60:63]
  s_xor_b32 s56, s88, 7518208
  s_waitcnt vmcnt(6)
  buffer_load_dwordx4 v[252:255], v9, s[44:47], s56 offen offset:0 nt
  s_waitcnt vmcnt(6)
  buffer_load_dwordx4 v[128:131], v6, s[36:39], s48 offen offset:0 nt
  v_perm_b32 v96, v228, v224, s60
  v_perm_b32 v100, v228, v224, s61
  v_perm_b32 v104, v229, v225, s60
  v_perm_b32 v108, v229, v225, s61
  v_perm_b32 v112, v230, v226, s60
  v_perm_b32 v116, v230, v226, s61
  v_perm_b32 v120, v231, v227, s60
  v_perm_b32 v124, v231, v227, s61
  s_waitcnt vmcnt(6)
  buffer_load_dwordx4 v[132:135], v6, s[36:39], s48 offen offset:2048 nt
  s_add_u32 s48, s48, 4096
  s_waitcnt vmcnt(6)
  buffer_load_dwordx4 v[136:139], v6, s[36:39], s48 offen offset:0 nt
  v_perm_b32 v97, v236, v232, s60
  v_perm_b32 v101, v236, v232, s61
  v_perm_b32 v105, v237, v233, s60
  v_perm_b32 v109, v237, v233, s61
  v_perm_b32 v113, v238, v234, s60
  v_perm_b32 v117, v238, v234, s61
  v_perm_b32 v121, v239, v235, s60
  v_perm_b32 v125, v239, v235, s61
  s_waitcnt vmcnt(6)
  buffer_load_dwordx4 v[140:143], v6, s[36:39], s48 offen offset:2048 nt
  s_add_u32 s48, s48, 4096
  s_waitcnt vmcnt(6)
  buffer_load_dwordx4 v[144:147], v6, s[36:39], s48 offen offset:0 nt
  v_perm_b32 v98, v244, v240, s60
  v_perm_b32 v102, v244, v240, s61
  v_perm_b32 v106, v245, v241, s60
  v_perm_b32 v110, v245, v241, s61
  v_perm_b32 v114, v246, v242, s60
  v_perm_b32 v118, v246, v242, s61
  v_perm_b32 v122, v247, v243, s60
  v_perm_b32 v126, v247, v243, s61
  s_waitcnt vmcnt(6)
  buffer_load_dwordx4 v[148:151], v6, s[36:39], s48 offen offset:2048 nt
  s_add_u32 s48, s48, 4096
  s_waitcnt vmcnt(6)
  buffer_load_dwordx4 v[152:155], v6, s[36:39], s48 offen offset:0 nt
  v_perm_b32 v99, v252, v248, s60
  v_perm_b32 v115, v254, v250, s60
  v_perm_b32 v103, v252, v248, s61
  v_perm_b32 v119, v254, v250, s61
  v_mfma_f32_16x16x32_bf16 v[48:51], v[96:99], v[88:91], v[48:51]
  v_mfma_f32_16x16x32_bf16 v[48:51], v[112:115], v[92:95], v[48:51]
  v_perm_b32 v107, v253, v249, s60
  v_perm_b32 v123, v255, v251, s60
  v_mfma_f32_16x16x32_bf16 v[52:55], v[100:103], v[88:91], v[52:55]
  v_mfma_f32_16x16x32_bf16 v[52:55], v[116:119], v[92:95], v[52:55]
  v_perm_b32 v111, v253, v249, s61
  v_perm_b32 v127, v255, v251, s61
  v_mfma_f32_16x16x32_bf16 v[56:59], v[104:107], v[88:91], v[56:59]
  v_mfma_f32_16x16x32_bf16 v[56:59], v[120:123], v[92:95], v[56:59]
  v_mfma_f32_16x16x32_bf16 v[60:63], v[108:111], v[88:91], v[60:63]
  v_mfma_f32_16x16x32_bf16 v[60:63], v[124:127], v[92:95], v[60:63]
  ds_write_b128 v5, v[48:51] offset:0
  s_nop 0
  ds_write_b128 v5, v[52:55] offset:16
  s_nop 2
  ds_write_b128 v5, v[56:59] offset:32
  s_nop 0
  ds_write_b128 v5, v[60:63] offset:48
L_orL:
  ds_read_b32 v20, v15
  ds_read_b128 v[96:99], v14 offset:0
  ds_read_b128 v[100:103], v14 offset:4224
  ds_read_b128 v[104:107], v14 offset:8448
  ds_read_b128 v[108:111], v14 offset:12672
  s_waitcnt lgkmcnt(4)
  v_cmp_eq_u32 vcc, -1, v20
  s_nop 0
  s_cbranch_vccz L_orL_ok
  s_sub_u32 s62, s62, 1
  s_cmp_gt_i32 s62, 0
  s_cbranch_scc1 L_orL
L_orL_ok:
  s_waitcnt lgkmcnt(3)
  v_pk_mul_f32 v[24:25], v[96:97], v[36:37]
  v_pk_mul_f32 v[26:27], v[98:99], v[36:37]
  s_waitcnt lgkmcnt(2)
  v_pk_fma_f32 v[24:25], v[100:101], v[38:39], v[24:25]
  v_pk_fma_f32 v[26:27], v[102:103], v[38:39], v[26:27]
  s_waitcnt lgkmcnt(1)
  v_pk_fma_f32 v[24:25], v[104:105], v[40:41], v[24:25]
  v_pk_fma_f32 v[26:27], v[106:107], v[40:41], v[26:27]
  s_waitcnt lgkmcnt(0)
  v_pk_fma_f32 v[24:25], v[108:109], v[42:43], v[24:25]
  v_pk_fma_f32 v[26:27], v[110:111], v[42:43], v[26:27]
  v_add_u32 v24, 0x10000, v24
  v_add_u32 v25, 0x10000, v25
  v_add_u32 v26, 0x10000, v26
  v_add_u32 v27, 0x10000, v27
  v_perm_b32 v24, v25, v24, s61
  v_perm_b32 v25, v27, v26, s61
  v_and_or_b32 v24, v24, v17, v18
  v_and_or_b32 v25, v25, v17, v19
  s_cmp_eq_u32 s92, 1
  s_cbranch_scc0 L_stoLf
  buffer_store_dwordx2 v[24:25], v16, s[28:31], s93 offen
  s_branch L_stoLd
L_stoLf:
  buffer_store_dwordx2 v[24:25], v16, s[28:31], s93 offen sc1
L_stoLd:
  s_waitcnt vmcnt(7)
  buffer_load_dwordx4 v[160:163], v7, s[32:35], s49 offen offset:0 nt
  s_add_u32 s49, s49, 16384
  s_waitcnt vmcnt(7)
  buffer_load_dwordx4 v[164:167], v7, s[32:35], s49 offen offset:0 nt
  s_add_u32 s49, s49, 16384
  s_waitcnt vmcnt(7)
  buffer_load_dwordx4 v[168:171], v7, s[32:35], s49 offen offset:0 nt
  s_add_u32 s49, s49, 16384
  s_waitcnt vmcnt(7)
  buffer_load_dwordx4 v[172:175], v7, s[32:35], s49 offen offset:0 nt
  ds_write_b32 v13, v13
  v_mov_b32 v24, 152992
L_rdone:
  ds_read_b128 v[20:23], v24
  s_waitcnt lgkmcnt(0)
  v_max3_u32 v25, v20, v21, v22
  v_max_u32 v25, v25, v23
  v_cmp_eq_u32 vcc, -1, v25
  s_nop 0
  s_cbranch_vccz L_rdone_ok
  s_sleep 1
  s_sub_u32 s62, s62, 1
  s_cmp_gt_i32 s62, 0
  s_cbranch_scc1 L_rdone
L_rdone_ok:
  s_sub_u32 s49, s49, 49152
  s_waitcnt vmcnt(15)
  buffer_load_dwordx4 v[176:179], v7, s[32:35], s49 offen offset:2048 nt
  s_add_u32 s49, s49, 16384
  s_waitcnt vmcnt(15)
  buffer_load_dwordx4 v[180:183], v7, s[32:35], s49 offen offset:2048 nt
  s_add_u32 s49, s49, 16384
  s_waitcnt vmcnt(15)
  buffer_load_dwordx4 v[184:187], v7, s[32:35], s49 offen offset:2048 nt
  s_add_u32 s49, s49, 16384
  s_waitcnt vmcnt(15)
  buffer_load_dwordx4 v[188:191], v7, s[32:35], s49 offen offset:2048 nt
  s_branch L_varend
L_H0:
  s_mov_b32 s60, 0x05040100
  s_mov_b32 s61, 0x07060302
  s_mov_b32 s62, 1000000
  s_mov_b32 s28, s26
  s_mov_b32 s29, s27
  s_mov_b32 s30, 1605632
  s_mov_b32 s31, 0x20000
  s_waitcnt vmcnt(0)
  v_xor_b32 v14, 2748638569, v14
  v_mov_b32 v13, 152960
  v_readfirstlane_b32 s96, v14
  s_getreg_b32 s52, hwreg(HW_REG_XCC_ID, 0, 4)
  s_xor_b32 s53, s96, 0x5a5a5a50
  s_and_b32 s53, s53, -16
  s_or_b32 s53, s53, s52
  s_and_b32 s54, s2, 7
  s_lshl_b32 s54, s54, 8
  s_and_b32 s55, s2, -8
  s_add_u32 s54, s54, s55
  s_add_u32 s54, s54, 249856
  v_mov_b32 v15, s53
  v_mov_b32 v16, 1073741824
  v_cmp_ne_u32 vcc, 0, v1
  s_nop 1
  v_cndmask_b32 v16, 0, v16, vcc
  buffer_store_dwordx2 v[14:15], v16, s[28:31], s54 offen
  v_lshlrev_b32 v20, 16, v40
  v_and_b32 v21, 0xffff0000, v40
  v_lshlrev_b32 v22, 16, v41
  v_and_b32 v23, 0xffff0000, v41
  v_lshlrev_b32 v24, 16, v42
  v_and_b32 v25, 0xffff0000, v42
  v_lshlrev_b32 v26, 16, v43
  v_and_b32 v27, 0xffff0000, v43
  v_lshlrev_b32 v28, 16, v44
  v_and_b32 v29, 0xffff0000, v44
  v_lshlrev_b32 v30, 16, v45
  v_and_b32 v31, 0xffff0000, v45
  v_lshlrev_b32 v32, 16, v46
  v_and_b32 v33, 0xffff0000, v46
  v_lshlrev_b32 v34, 16, v47
  v_and_b32 v35, 0xffff0000, v47
  v_add_f32 v8, v20, v21
  v_add_f32 v8, v8, v22
  v_add_f32 v8, v8, v23
  v_add_f32 v8, v8, v24
  v_add_f32 v8, v8, v25
  v_add_f32 v8, v8, v26
  v_add_f32 v8, v8, v27
  v_add_f32 v8, v8, v28
  v_add_f32 v8, v8, v29
  v_add_f32 v8, v8, v30
  v_add_f32 v8, v8, v31
  v_add_f32 v8, v8, v32
  v_add_f32 v8, v8, v33
  v_add_f32 v8, v8, v34
  v_add_f32 v8, v8, v35
  s_nop 1
  v_add_f32_dpp v8, v8, v8 row_ror:8 row_mask:0xf bank_mask:0xf
  s_nop 1
  v_add_f32_dpp v8, v8, v8 row_ror:4 row_mask:0xf bank_mask:0xf
  s_nop 1
  v_add_f32_dpp v8, v8, v8 row_ror:2 row_mask:0xf bank_mask:0xf
  s_nop 1
  v_add_f32_dpp v8, v8, v8 row_ror:1 row_mask:0xf bank_mask:0xf
  v_mov_b32 v9, v8
  s_nop 1
  v_permlane16_swap_b32 v9, v8
  v_add_f32 v8, v8, v9
  v_mov_b32 v9, v8
  s_nop 1
  v_permlane32_swap_b32 v9, v8
  v_add_f32 v8, v8, v9
  v_mul_f32 v8, 0x3a800000, v8
  v_sub_f32 v9, v20, v8
  v_mul_f32 v10, v9, v9
  v_sub_f32 v9, v21, v8
  v_fmac_f32 v10, v9, v9
  v_sub_f32 v9, v22, v8
  v_fmac_f32 v10, v9, v9
  v_sub_f32 v9, v23, v8
  v_fmac_f32 v10, v9, v9
  v_sub_f32 v9, v24, v8
  v_fmac_f32 v10, v9, v9
  v_sub_f32 v9, v25, v8
  v_fmac_f32 v10, v9, v9
  v_sub_f32 v9, v26, v8
  v_fmac_f32 v10, v9, v9
  v_sub_f32 v9, v27, v8
  v_fmac_f32 v10, v9, v9
  v_sub_f32 v9, v28, v8
  v_fmac_f32 v10, v9, v9
  v_sub_f32 v9, v29, v8
  v_fmac_f32 v10, v9, v9
  v_sub_f32 v9, v30, v8
  v_fmac_f32 v10, v9, v9
  v_sub_f32 v9, v31, v8
  v_fmac_f32 v10, v9, v9
  v_sub_f32 v9, v32, v8
  v_fmac_f32 v10, v9, v9
  v_sub_f32 v9, v33, v8
  v_fmac_f32 v10, v9, v9
  v_sub_f32 v9, v34, v8
  v_fmac_f32 v10, v9, v9
  v_sub_f32 v9, v35, v8
  v_fmac_f32 v10, v9, v9
  s_nop 1
  v_add_f32_dpp v10, v10, v10 row_ror:8 row_mask:0xf bank_mask:0xf
  s_nop 1
  v_add_f32_dpp v10, v10, v10 row_ror:4 row_mask:0xf bank_mask:0xf
  s_nop 1
  v_add_f32_dpp v10, v10, v10 row_ror:2 row_mask:0xf bank_mask:0xf
  s_nop 1
  v_add_f32_dpp v10, v10, v10 row_ror:1 row_mask:0xf bank_mask:0xf
  v_mov_b32 v9, v10
  s_nop 1
  v_permlane16_swap_b32 v9, v10
  v_add_f32 v10, v10, v9
  v_mov_b32 v9, v10
  s_nop 1
  v_permlane32_swap_b32 v9, v10
  v_add_f32 v10, v10, v9
  v_mul_f32 v10, 0x3a800000, v10
  v_cvt_pk_bf16_f32 v8, v8, v8
  v_lshlrev_b32 v8, 16, v8
  v_cvt_pk_bf16_f32 v10, v10, v10
  v_lshlrev_b32 v10, 16, v10
  v_add_f32 v10, 0x3727c5ac, v10
  v_cvt_pk_bf16_f32 v10, v10, v10
  v_lshlrev_b32 v10, 16, v10
  v_sqrt_f32 v10, v10
  s_nop 0
  v_cvt_pk_bf16_f32 v10, v10, v10
  v_lshlrev_b32 v10, 16, v10
  v_rcp_f32 v11, v10
  s_nop 0
  v_fma_f32 v12, -v10, v11, 1.0
  v_fma_f32 v11, v12, v11, v11
  v_sub_f32 v20, v20, v8
  v_sub_f32 v21, v21, v8
  v_cvt_pk_bf16_f32 v20, v20, v21
  v_and_b32 v21, 0xffff0000, v20
  v_lshlrev_b32 v20, 16, v20
  v_mul_f32 v20, v20, v11
  v_mul_f32 v21, v21, v11
  v_cvt_pk_bf16_f32 v40, v20, v21
  v_sub_f32 v22, v22, v8
  v_sub_f32 v23, v23, v8
  v_cvt_pk_bf16_f32 v22, v22, v23
  v_and_b32 v23, 0xffff0000, v22
  v_lshlrev_b32 v22, 16, v22
  v_mul_f32 v22, v22, v11
  v_mul_f32 v23, v23, v11
  v_cvt_pk_bf16_f32 v41, v22, v23
  v_sub_f32 v24, v24, v8
  v_sub_f32 v25, v25, v8
  v_cvt_pk_bf16_f32 v24, v24, v25
  v_and_b32 v25, 0xffff0000, v24
  v_lshlrev_b32 v24, 16, v24
  v_mul_f32 v24, v24, v11
  v_mul_f32 v25, v25, v11
  v_cvt_pk_bf16_f32 v42, v24, v25
  v_sub_f32 v26, v26, v8
  v_sub_f32 v27, v27, v8
  v_cvt_pk_bf16_f32 v26, v26, v27
  v_and_b32 v27, 0xffff0000, v26
  v_lshlrev_b32 v26, 16, v26
  v_mul_f32 v26, v26, v11
  v_mul_f32 v27, v27, v11
  v_cvt_pk_bf16_f32 v43, v26, v27
  v_sub_f32 v28, v28, v8
  v_sub_f32 v29, v29, v8
  v_cvt_pk_bf16_f32 v28, v28, v29
  v_and_b32 v29, 0xffff0000, v28
  v_lshlrev_b32 v28, 16, v28
  v_mul_f32 v28, v28, v11
  v_mul_f32 v29, v29, v11
  v_cvt_pk_bf16_f32 v44, v28, v29
  v_sub_f32 v30, v30, v8
  v_sub_f32 v31, v31, v8
  v_cvt_pk_bf16_f32 v30, v30, v31
  v_and_b32 v31, 0xffff0000, v30
  v_lshlrev_b32 v30, 16, v30
  v_mul_f32 v30, v30, v11
  v_mul_f32 v31, v31, v11
  v_cvt_pk_bf16_f32 v45, v30, v31
  v_sub_f32 v32, v32, v8
  v_sub_f32 v33, v33, v8
  v_cvt_pk_bf16_f32 v32, v32, v33
  v_and_b32 v33, 0xffff0000, v32
  v_lshlrev_b32 v32, 16, v32
  v_mul_f32 v32, v32, v11
  v_mul_f32 v33, v33, v11
  v_cvt_pk_bf16_f32 v46, v32, v33
  v_sub_f32 v34, v34, v8
  v_sub_f32 v35, v35, v8
  v_cvt_pk_bf16_f32 v34, v34, v35
  v_and_b32 v35, 0xffff0000, v34
  v_lshlrev_b32 v34, 16, v34
  v_mul_f32 v34, v34, v11
  v_mul_f32 v35, v35, v11
  v_cvt_pk_bf16_f32 v47, v34, v35
  s_barrier
  v_add_u32 v7, 147968, v7
  ds_write_b128 v7, v[40:43]
  ds_write_b128 v7, v[44:47] offset:16
  ds_write_b32 v13, v14 offset:12
  s_waitcnt lgkmcnt(0)
  ds_write_b32 v13, v13 offset:0
  v_and_b32 v18, 7, v1
  s_mul_i32 s52, s55, 56
  s_add_u32 s52, s52, 229376
  v_mov_b32 v12, 152192
L_sdone:
  ds_read_b32 v11, v12
  s_waitcnt lgkmcnt(0)
  v_cmp_eq_u32 vcc, -1, v11
  s_nop 0
  s_cbranch_vccz L_sdone_ok
  s_sleep 4
  s_sub_u32 s62, s62, 1
  s_cmp_gt_i32 s62, 0
  s_cbranch_scc1 L_sdone
L_sdone_ok:
  v_min_u32 v12, 6, v18
  v_lshrrev_b32 v10, 3, v1
  v_mul_u32_u24 v10, 7, v10
  v_add_lshl_u32 v10, v10, v12, 2
  v_lshlrev_b32 v12, 2, v10
  v_and_b32 v12, 16, v12
  v_bfe_u32 v12, s96, v12, 16
  buffer_load_dword v32, v10, s[28:31], s52 offen offset:0 sc1
  buffer_load_dword v33, v10, s[28:31], s52 offen offset:224 sc1
L_hg:
  s_waitcnt vmcnt(0)
  v_xor_b32 v20, v12, v32
  v_xor_b32 v21, v12, v33
  v_or_b32 v24, v20, v21
  v_and_b32 v24, 0xffff, v24
  v_cmp_ne_u32 vcc, 0, v24
  s_nop 0
  s_cbranch_vccz L_hg_ok
  s_sleep 8
  v_and_b32 v24, 0xffff, v20
  v_cmp_ne_u32 vcc, 0, v24
  s_nop 0
  s_cbranch_vccz L_hg_s0
  buffer_load_dword v32, v10, s[28:31], s52 offen offset:0 sc1
L_hg_s0:
  v_and_b32 v24, 0xffff, v21
  v_cmp_ne_u32 vcc, 0, v24
  s_nop 0
  s_cbranch_vccz L_hg_s1
  buffer_load_dword v33, v10, s[28:31], s52 offen offset:224 sc1
L_hg_s1:
  s_waitcnt vmcnt(0)
  s_sub_u32 s62, s62, 1
  s_cmp_gt_i32 s62, 0
  s_cbranch_scc1 L_hg
L_hg_ok:
  v_cmp_ne_u32 vcc, 7, v18
  v_and_b32 v10, 62, v1
  v_lshlrev_b32 v10, 1, v10
  v_add_u32 v10, 152448, v10
  v_cndmask_b32 v20, 0, v20, vcc
  s_nop 1
  v_mov_b32_dpp v22, v20 quad_perm:[0,0,2,2] row_mask:0xf bank_mask:0xf
  v_mov_b32_dpp v23, v20 quad_perm:[1,1,3,3] row_mask:0xf bank_mask:0xf
  v_perm_b32 v20, v23, v22, s61
  ds_write_b32 v10, v20 offset:0
  v_cndmask_b32 v21, 0, v21, vcc
  s_nop 1
  v_mov_b32_dpp v22, v21 quad_perm:[0,0,2,2] row_mask:0xf bank_mask:0xf
  v_mov_b32_dpp v23, v21 quad_perm:[1,1,3,3] row_mask:0xf bank_mask:0xf
  v_perm_b32 v21, v23, v22, s61
  ds_write_b32 v10, v21 offset:128
  s_cmp_ge_u32 s2, 224
  s_cbranch_scc1 L_ofin
L_H0b:
  s_and_b32 s50, s2, -8
  s_lshl_b32 s50, s50, 8
  s_add_u32 s50, s50, 1474560
  v_mov_b32 v20, s96
  v_and_b32 v19, 7, v1
  v_lshlrev_b32 v21, 2, v19
  v_alignbit_b32 v20, v20, v20, v21
  v_alignbit_b32 v28, v20, v20, 0
  v_and_b32 v28, 0x10001, v28
  v_alignbit_b32 v29, v20, v20, 1
  v_and_b32 v29, 0x10001, v29
  v_alignbit_b32 v30, v20, v20, 2
  v_and_b32 v30, 0x10001, v30
  v_alignbit_b32 v31, v20, v20, 3
  v_and_b32 v31, 0x10001, v31
  v_and_b32 v10, 1, v1
  v_lshlrev_b32 v10, 4, v10
  v_mov_b32 v11, 0x3f80
  v_lshlrev_b32 v10, v10, v11
  v_bfe_u32 v11, v1, 1, 3
  v_cmp_eq_u32 vcc, 0, v11
  s_nop 1
  v_cndmask_b32 v24, 0, v10, vcc
  v_cmp_eq_u32 vcc, 1, v11
  s_nop 1
  v_cndmask_b32 v25, 0, v10, vcc
  v_cmp_eq_u32 vcc, 2, v11
  s_nop 1
  v_cndmask_b32 v26, 0, v10, vcc
  v_cmp_eq_u32 vcc, 3, v11
  s_nop 1
  v_cndmask_b32 v27, 0, v10, vcc
  v_and_b32 v10, 15, v1
  v_lshlrev_b32 v10, 4, v10
  v_and_b32 v8, 16, v1
  v_lshrrev_b32 v8, 1, v8
  v_add_u32 v10, v10, v8
  v_add_u32 v10, 152704, v10
  v_lshlrev_b32 v8, 4, v1
  v_mov_b32 v16, 152976
L_f3:
  ds_read_b128 v[40:43], v16
  s_waitcnt lgkmcnt(0)
  v_max3_u32 v22, v40, v41, v42
  v_max_u32 v22, v22, v43
  v_cmp_eq_u32 vcc, -1, v22
  s_nop 0
  s_cbranch_vccz L_f3_ok
  s_sleep 2
  s_sub_u32 s62, s62, 1
  s_cmp_gt_i32 s62, 0
  s_cbranch_scc1 L_f3
L_f3_ok:
  buffer_load_dwordx4 v[64:67], v8, s[28:31], s50 offen offset:0 sc1
  buffer_load_dwordx4 v[68:71], v8, s[28:31], s50 offen offset:1024 sc1
L_og:
  s_waitcnt vmcnt(1)
  v_xor_b32 v40, v28, v64
  v_xor_b32 v41, v29, v65
  v_xor_b32 v42, v30, v66
  v_xor_b32 v43, v31, v67
  v_or3_b32 v20, v40, v41, v42
  v_or_b32 v20, v20, v43
  v_mfma_f32_16x16x32_bf16 v[48:51], v[24:27], v[40:43], 0
  s_waitcnt vmcnt(0)
  v_xor_b32 v44, v28, v68
  v_xor_b32 v45, v29, v69
  v_xor_b32 v46, v30, v70
  v_xor_b32 v47, v31, v71
  v_or3_b32 v21, v44, v45, v46
  v_or_b32 v21, v21, v47
  v_mfma_f32_16x16x32_bf16 v[48:51], v[24:27], v[44:47], v[48:51]
  v_or_b32 v22, v20, v21
  v_and_b32 v22, 0x10001, v22
  v_cmp_ne_u32 vcc, 0, v22
  s_nop 0
  s_cbranch_vccz L_og_ok
  buffer_load_dwordx4 v[64:67], v8, s[28:31], s50 offen offset:0 sc1
  buffer_load_dwordx4 v[68:71], v8, s[28:31], s50 offen offset:1024 sc1
  s_sub_u32 s62, s62, 1
  s_cmp_gt_i32 s62, 0
  s_cbranch_scc1 L_og
  s_waitcnt vmcnt(0)
L_og_ok:
  s_mov_b32 exec_hi, 0
  s_nop 1
  v_cvt_pk_bf16_f32 v20, v48, v49
  v_cvt_pk_bf16_f32 v21, v50, v51
  ds_write_b64 v10, v[20:21]
  s_waitcnt lgkmcnt(0)
  s_endpgm
L_H123:
  v_mov_b32 v16, -1
  v_mov_b32 v17, -1
  v_mov_b32 v18, -1
  v_mov_b32 v19, -1
  v_lshlrev_b32 v13, 4, v1
  v_add_u32 v12, 150016, v13
  ds_write_b128 v12, v[16:19] offset:0
  ds_write_b128 v12, v[16:19] offset:1024
  ds_write_b128 v12, v[16:19] offset:2048
  ds_write_b128 v12, v[16:19] offset:3072
  ds_write_b128 v12, v[16:19] offset:4096
  ds_write_b128 v12, v[16:19] offset:5120
  ds_write_b128 v12, v[16:19] offset:6144
  v_lshrrev_b32 v12, 4, v1
  v_mul_u32_u24 v12, 4224, v12
  v_add_u32 v12, 135276, v12
  ds_write_b32 v12, v16
  s_waitcnt lgkmcnt(0)
  s_barrier
  s_mov_b32 s60, 0x05040100
  s_mov_b32 s61, 0x07060302
  s_mov_b32 s62, 1000000
  s_mov_b32 s28, s26
  s_mov_b32 s29, s27
  s_mov_b32 s30, 1605632
  s_mov_b32 s31, 0x20000
  v_mov_b32 v9, 1073741824
  v_mov_b32 v15, 0xffffff00
  v_lshrrev_b32 v2, 4, v1
  v_and_b32 v3, 15, v1
  v_and_b32 v14, 7, v1
  s_and_b32 s55, s2, 7
  s_lshr_b32 s54, s2, 3
  v_mov_b32 v12, 152960
L_f0h:
  ds_read_b32 v11, v12
  s_waitcnt lgkmcnt(0)
  v_cmp_eq_u32 vcc, -1, v11
  s_nop 0
  s_cbranch_vccz L_f0h_ok
  s_sleep 4
  s_sub_u32 s62, s62, 1
  s_cmp_gt_i32 s62, 0
  s_cbranch_scc1 L_f0h
L_f0h_ok:
  v_mov_b32 v11, 152960
  ds_read_b32 v11, v11 offset:12
  s_waitcnt lgkmcnt(0)
  v_readfirstlane_b32 s96, v11
  s_nop 0
  s_bfe_u32 s97, s96, 524288
  s_bfe_u32 s98, s96, 524296
  s_bfe_u32 s99, s96, 524304
  s_bfe_u32 s100, s96, 524312
  s_cmp_eq_u32 s3, 2
  s_cbranch_scc1 L_H2
  s_cmp_eq_u32 s3, 3
  s_cbranch_scc1 L_H3
  s_bfe_u32 s59, s2, 0x20003
  s_add_u32 s53, s2, s59
  s_and_b32 s53, s53, 7
  s_lshl3_add_u32 s53, s59, s53
  s_lshr_b32 s58, s2, 5
  s_lshl_b32 s59, s53, 12
  s_add_u32 s59, s59, 1343488
  s_lshl_b32 s58, s58, 9
  s_add_u32 s58, s58, s59
  v_mov_b32 v12, 152968
L_fm1:
  ds_read_b32 v11, v12
  s_waitcnt lgkmcnt(0)
  v_cmp_eq_u32 vcc, -1, v11
  s_nop 0
  s_cbranch_vccz L_fm1_ok
  s_sleep 2
  s_sub_u32 s62, s62, 1
  s_cmp_gt_i32 s62, 0
  s_cbranch_scc1 L_fm1
L_fm1_ok:
  v_readfirstlane_b32 s92, v11
  v_add_u32 v10, 153088, v13
  v_cmp_gt_u32 vcc, 32, v1
  s_nop 1
  v_cndmask_b32 v8, v9, v13, vcc
L_qr:
  ds_read_b128 v[128:131], v10 offset:0
  ds_read_b128 v[132:135], v10 offset:1024
  s_waitcnt lgkmcnt(0)
  v_max3_u32 v20, v128, v129, v130
  v_max3_u32 v20, v20, v131, v132
  v_max3_u32 v20, v20, v133, v134
  v_max_u32 v20, v20, v135
  v_cmp_eq_u32 vcc, -1, v20
  s_nop 0
  s_cbranch_vccz L_qr_ok
  s_sleep 2
  s_sub_u32 s62, s62, 1
  s_cmp_gt_i32 s62, 0
  s_cbranch_scc1 L_qr
L_qr_ok:
  v_add_f32 v128, v128, v132
  v_add_f32 v129, v129, v133
  v_add_f32 v130, v130, v134
  v_add_f32 v131, v131, v135
  v_mov_b32 v132, v128
  v_mov_b32 v133, v129
  v_mov_b32 v134, v130
  v_mov_b32 v135, v131
  v_permlane32_swap_b32 v132, v128
  v_permlane32_swap_b32 v133, v129
  v_permlane32_swap_b32 v134, v130
  v_permlane32_swap_b32 v135, v131
  v_add_f32 v128, v128, v132
  v_add_f32 v129, v129, v133
  v_add_f32 v130, v130, v134
  v_add_f32 v131, v131, v135
  v_add_u32 v128, 128, v128
  v_add_u32 v129, 128, v129
  v_add_u32 v130, 128, v130
  v_add_u32 v131, 128, v131
  v_and_or_b32 v128, v128, v15, s97
  v_and_or_b32 v129, v129, v15, s98
  v_and_or_b32 v130, v130, v15, s99
  v_and_or_b32 v131, v131, v15, s100
  s_cmp_eq_u32 s92, 1
  s_cbranch_scc0 L_stqf
  buffer_store_dwordx4 v[128:131], v8, s[28:31], s58 offen
  s_branch L_stqd
L_stqf:
  buffer_store_dwordx4 v[128:131], v8, s[28:31], s58 offen sc1
L_stqd:
  s_and_b32 s88, s96, 0xffff
  s_lshr_b32 s89, s96, 16
  s_cmp_lt_u32 s2, 224
  s_cbranch_scc1 L_qf0
  s_lshl_b32 s57, s53, 9
  s_add_u32 s57, s57, 1327104
  s_waitcnt vmcnt(0)
  buffer_load_dwordx4 v[128:131], v13, s[28:31], s59 offen offset:0 sc1
  buffer_load_dwordx4 v[132:135], v13, s[28:31], s59 offen offset:1024 sc1
  buffer_load_dwordx4 v[136:139], v13, s[28:31], s59 offen offset:2048 sc1
  buffer_load_dwordx4 v[140:143], v13, s[28:31], s59 offen offset:3072 sc1
L_qp:
  s_waitcnt vmcnt(0)
  v_xor_b32 v144, s97, v128
  v_xor_b32 v145, s98, v129
  v_xor_b32 v146, s99, v130
  v_xor_b32 v147, s100, v131
  v_or3_b32 v20, v144, v145, v146
  v_or_b32 v20, v20, v147
  v_xor_b32 v148, s97, v132
  v_xor_b32 v149, s98, v133
  v_xor_b32 v150, s99, v134
  v_xor_b32 v151, s100, v135
  v_or3_b32 v21, v148, v149, v150
  v_or_b32 v21, v21, v151
  v_xor_b32 v152, s97, v136
  v_xor_b32 v153, s98, v137
  v_xor_b32 v154, s99, v138
  v_xor_b32 v155, s100, v139
  v_or3_b32 v22, v152, v153, v154
  v_or_b32 v22, v22, v155
  v_xor_b32 v156, s97, v140
  v_xor_b32 v157, s98, v141
  v_xor_b32 v158, s99, v142
  v_xor_b32 v159, s100, v143
  v_or3_b32 v23, v156, v157, v158
  v_or_b32 v23, v23, v159
  v_or3_b32 v24, v20, v21, v22
  v_or_b32 v24, v24, v23
  v_and_b32 v24, 0xff, v24
  v_cmp_ne_u32 vcc, 0, v24
  s_nop 0
  s_cbranch_vccz L_qp_ok
  s_sleep 4
  v_and_b32 v24, 0xff, v20
  v_cmp_ne_u32 vcc, 0, v24
  s_nop 0
  s_cbranch_vccz L_qp_s0
  buffer_load_dwordx4 v[128:131], v13, s[28:31], s59 offen offset:0 sc1
L_qp_s0:
  v_and_b32 v24, 0xff, v21
  v_cmp_ne_u32 vcc, 0, v24
  s_nop 0
  s_cbranch_vccz L_qp_s1
  buffer_load_dwordx4 v[132:135], v13, s[28:31], s59 offen offset:1024 sc1
L_qp_s1:
  v_and_b32 v24, 0xff, v22
  v_cmp_ne_u32 vcc, 0, v24
  s_nop 0
  s_cbranch_vccz L_qp_s2
  buffer_load_dwordx4 v[136:139], v13, s[28:31], s59 offen offset:2048 sc1
L_qp_s2:
  v_and_b32 v24, 0xff, v23
  v_cmp_ne_u32 vcc, 0, v24
  s_nop 0
  s_cbranch_vccz L_qp_s3
  buffer_load_dwordx4 v[140:143], v13, s[28:31], s59 offen offset:3072 sc1
L_qp_s3:
  s_waitcnt vmcnt(0)
  s_sub_u32 s62, s62, 1
  s_cmp_gt_i32 s62, 0
  s_cbranch_scc1 L_qp
L_qp_ok:
  v_add_f32 v144, v144, v148
  v_add_f32 v152, v152, v156
  v_add_f32 v145, v145, v149
  v_add_f32 v153, v153, v157
  v_add_f32 v146, v146, v150
  v_add_f32 v154, v154, v158
  v_add_f32 v147, v147, v151
  v_add_f32 v155, v155, v159
  v_add_f32 v144, v144, v152
  v_add_f32 v145, v145, v153
  v_add_f32 v146, v146, v154
  v_add_f32 v147, v147, v155
  v_mov_b32 v148, v144
  v_mov_b32 v149, v145
  v_mov_b32 v150, v146
  v_mov_b32 v151, v147
  v_permlane32_swap_b32 v148, v144
  v_permlane32_swap_b32 v149, v145
  v_permlane32_swap_b32 v150, v146
  v_permlane32_swap_b32 v151, v147
  v_add_f32 v144, v144, v148
  v_add_f32 v145, v145, v149
  v_add_f32 v146, v146, v150
  v_add_f32 v147, v147, v151
  v_cvt_pk_bf16_f32 v20, v144, v144
  v_lshlrev_b32 v20, 16, v20
  v_or_b32 v20, s88, v20
  v_cvt_pk_bf16_f32 v21, v145, v145
  v_lshlrev_b32 v21, 16, v21
  v_or_b32 v21, s89, v21
  v_cvt_pk_bf16_f32 v22, v146, v146
  v_lshlrev_b32 v22, 16, v22
  v_or_b32 v22, s88, v22
  v_cvt_pk_bf16_f32 v23, v147, v147
  v_lshlrev_b32 v23, 16, v23
  v_or_b32 v23, s89, v23
  buffer_store_dwordx4 v[20:23], v8, s[28:31], s57 offen sc1
  s_waitcnt vmcnt(0)
L_qf0:
  v_mov_b32 v12, 152964
L_f1:
  ds_read_b32 v11, v12
  s_waitcnt lgkmcnt(0)
  v_cmp_eq_u32 vcc, -1, v11
  s_nop 0
  s_cbranch_vccz L_f1_ok
  s_sleep 2
  s_sub_u32 s62, s62, 1
  s_cmp_gt_i32 s62, 0
  s_cbranch_scc1 L_f1
L_f1_ok:
  s_bfe_u32 s52, s2, 0x20003
  s_lshl_b32 s52, s52, 12
  s_add_u32 s52, s52, 1327104
  buffer_load_dwordx4 v[128:131], v13, s[28:31], s52 offen offset:0 sc1
  buffer_load_dwordx4 v[132:135], v13, s[28:31], s52 offen offset:1024 sc1
  buffer_load_dwordx4 v[136:139], v13, s[28:31], s52 offen offset:2048 sc1
  buffer_load_dwordx4 v[140:143], v13, s[28:31], s52 offen offset:3072 sc1
L_qf:
  s_waitcnt vmcnt(0)
  v_xor_b32 v144, s88, v128
  v_xor_b32 v145, s89, v129
  v_xor_b32 v146, s88, v130
  v_xor_b32 v147, s89, v131
  v_or3_b32 v20, v144, v145, v146
  v_or_b32 v20, v20, v147
  v_xor_b32 v148, s88, v132
  v_xor_b32 v149, s89, v133
  v_xor_b32 v150, s88, v134
  v_xor_b32 v151, s89, v135
  v_or3_b32 v21, v148, v149, v150
  v_or_b32 v21, v21, v151
  v_xor_b32 v152, s88, v136
  v_xor_b32 v153, s89, v137
  v_xor_b32 v154, s88, v138
  v_xor_b32 v155, s89, v139
  v_or3_b32 v22, v152, v153, v154
  v_or_b32 v22, v22, v155
  v_xor_b32 v156, s88, v140
  v_xor_b32 v157, s89, v141
  v_xor_b32 v158, s88, v142
  v_xor_b32 v159, s89, v143
  v_or3_b32 v23, v156, v157, v158
  v_or_b32 v23, v23, v159
  v_or3_b32 v24, v20, v21, v22
  v_or_b32 v24, v24, v23
  v_and_b32 v24, 0xffff, v24
  v_cmp_ne_u32 vcc, 0, v24
  s_nop 0
  s_cbranch_vccz L_qf_ok
  s_sleep 8
  v_and_b32 v24, 0xffff, v20
  v_cmp_ne_u32 vcc, 0, v24
  s_nop 0
  s_cbranch_vccz L_qf_s0
  s_mov_b64 exec, vcc
  buffer_load_dwordx4 v[128:131], v13, s[28:31], s52 offen offset:0 sc1
  s_mov_b64 exec, -1
L_qf_s0:
  v_and_b32 v24, 0xffff, v21
  v_cmp_ne_u32 vcc, 0, v24
  s_nop 0
  s_cbranch_vccz L_qf_s1
  s_mov_b64 exec, vcc
  buffer_load_dwordx4 v[132:135], v13, s[28:31], s52 offen offset:1024 sc1
  s_mov_b64 exec, -1
L_qf_s1:
  v_and_b32 v24, 0xffff, v22
  v_cmp_ne_u32 vcc, 0, v24
  s_nop 0
  s_cbranch_vccz L_qf_s2
  s_mov_b64 exec, vcc
  buffer_load_dwordx4 v[136:139], v13, s[28:31], s52 offen offset:2048 sc1
  s_mov_b64 exec, -1
L_qf_s2:
  v_and_b32 v24, 0xffff, v23
  v_cmp_ne_u32 vcc, 0, v24
  s_nop 0
  s_cbranch_vccz L_qf_s3
  s_mov_b64 exec, vcc
  buffer_load_dwordx4 v[140:143], v13, s[28:31], s52 offen offset:3072 sc1
  s_mov_b64 exec, -1
L_qf_s3:
  s_waitcnt vmcnt(0)
  s_sub_u32 s62, s62, 1
  s_cmp_gt_i32 s62, 0
  s_cbranch_scc1 L_qf
L_qf_ok:
  v_lshrrev_b32 v11, 5, v1
  v_lshlrev_b32 v11, 1, v11
  v_add_lshl_u32 v11, v11, v1, 3
  v_add_u32 v11, 150016, v11
  v_perm_b32 v20, v145, v144, s61
  v_perm_b32 v21, v147, v146, s61
  ds_write_b64 v11, v[20:21] offset:0
  v_perm_b32 v22, v149, v148, s61
  v_perm_b32 v23, v151, v150, s61
  ds_write_b64 v11, v[22:23] offset:544
  v_perm_b32 v24, v153, v152, s61
  v_perm_b32 v25, v155, v154, s61
  ds_write_b64 v11, v[24:25] offset:1088
  v_perm_b32 v26, v157, v156, s61
  v_perm_b32 v27, v159, v158, s61
  ds_write_b64 v11, v[26:27] offset:1632
  s_cmp_ge_u32 s2, 224
  s_cbranch_scc1 L_ofin
L_H1b:
  s_mov_b32 s40, s22
  s_mov_b32 s41, s23
  s_mov_b32 s42, 2048
  s_mov_b32 s43, 0x20000
  s_mov_b32 s44, s4
  s_mov_b32 s45, s5
  s_mov_b32 s46, 2048
  s_mov_b32 s47, 0x20000
  s_lshl_b32 s50, s55, 5
  s_add_u32 s50, s50, s54
  s_lshl_b32 s55, s50, 3
  s_lshr_b32 s51, s50, 5
  s_lshl_b32 s51, s51, 16
  s_lshl_b32 s50, s54, 5
  s_add_u32 s50, s50, s51
  s_add_u32 s50, s50, 786432
  s_add_u32 s51, s50, 32768
  v_lshrrev_b32 v10, 1, v1
  v_lshlrev_b32 v10, 10, v10
  v_and_b32 v12, 1, v1
  v_lshl_add_u32 v10, v12, 4, v10
  v_lshlrev_b32 v12, 1, v2
  buffer_load_ushort v15, v12, s[44:47], s55 offen
  v_and_b32 v14, 15, v1
  v_cmp_eq_u32 vcc, 0, v14
  s_nop 1
  v_cndmask_b32 v13, v9, v12, vcc
  s_xor_b32 s57, s96, 1546328726
  v_mov_b32 v17, s57
  v_or_b32 v18, s2, v1
  v_mov_b32 v19, 245760
  v_cmp_eq_u32 vcc, 0, v18
  s_nop 1
  v_cndmask_b32 v16, v9, v19, vcc
  s_bfe_u32 s97, s96, 786432
  s_bfe_u32 s98, s96, 786444
  s_bfe_u32 s99, s96, 786452
  s_bfe_u32 s100, s96, 786438
  s_waitcnt vmcnt(0)
  v_lshlrev_b32 v15, 16, v15
  v_mov_b32 v12, 152704
L_o16:
  ds_read_b32 v11, v12
  s_waitcnt lgkmcnt(0)
  v_cmp_eq_u32 vcc, -1, v11
  s_nop 0
  s_cbranch_vccz L_o16_ok
  s_sleep 1
  s_sub_u32 s62, s62, 1
  s_cmp_gt_i32 s62, 0
  s_cbranch_scc1 L_o16
L_o16_ok:
  buffer_load_dwordx4 v[36:39], v10, s[28:31], s50 offen sc1
  buffer_load_dwordx4 v[40:43], v10, s[28:31], s51 offen sc1
L_sg:
  s_waitcnt vmcnt(0)
  v_xor_b32 v28, s97, v36
  v_xor_b32 v29, s98, v37
  v_xor_b32 v30, s99, v38
  v_xor_b32 v31, s100, v39
  v_or3_b32 v20, v28, v29, v30
  v_or_b32 v20, v20, v31
  v_xor_b32 v32, s97, v40
  v_xor_b32 v33, s98, v41
  v_xor_b32 v34, s99, v42
  v_xor_b32 v35, s100, v43
  v_or3_b32 v21, v32, v33, v34
  v_or_b32 v21, v21, v35
  v_or_b32 v22, v20, v21
  v_and_b32 v22, 0xfff, v22
  v_cmp_ne_u32 vcc, 0, v22
  s_nop 0
  s_cbranch_vccz L_sg_ok
  s_mov_b64 exec, vcc
  buffer_load_dwordx4 v[36:39], v10, s[28:31], s50 offen sc1
  buffer_load_dwordx4 v[40:43], v10, s[28:31], s51 offen sc1
  s_mov_b64 exec, -1
  s_waitcnt vmcnt(0)
  s_sub_u32 s62, s62, 1
  s_cmp_gt_i32 s62, 0
  s_cbranch_scc1 L_sg
L_sg_ok:
  v_pk_add_f32 v[28:29], v[28:29], v[32:33]
  v_pk_add_f32 v[30:31], v[30:31], v[34:35]
  s_nop 1
  v_permlane32_swap_b32 v28, v30
  v_permlane32_swap_b32 v29, v31
  v_add_f32 v28, v28, v30
  v_add_f32 v29, v29, v31
  s_nop 1
  v_permlane16_swap_b32 v28, v29
  v_add_f32 v28, v28, v29
  s_nop 1
  v_add_f32_dpp v28, v28, v28 row_ror:8 row_mask:0xf bank_mask:0xf
  s_nop 1
  v_add_f32_dpp v28, v28, v28 row_ror:4 row_mask:0xf bank_mask:0xf
  s_nop 1
  v_add_f32_dpp v28, v28, v28 row_ror:2 row_mask:0xf bank_mask:0xf
  v_cvt_pk_bf16_f32 v28, v28, v28
  v_lshlrev_b32 v28, 16, v28
  v_mul_f32 v25, 0xbfb8aa3b, v28
  v_exp_f32 v25, v25
  s_nop 0
  v_add_f32 v25, 1.0, v25
  v_rcp_f32 v25, v25
  s_nop 0
  v_mul_f32 v24, v28, v25
  v_cvt_pk_bf16_f32 v24, v24, v24
  v_lshlrev_b32 v24, 16, v24
  s_nop 1
  v_mul_f32_dpp v28, v24, v28 quad_perm:[1,1,3,3] row_mask:0xf bank_mask:0xf
  v_cvt_pk_bf16_f32 v28, v28, v28
  v_lshlrev_b32 v28, 16, v28
  v_add_f32 v28, v28, v15
  v_cvt_pk_bf16_f32 v28, v28, v28
  buffer_store_short v28, v13, s[40:43], s55 offen
  buffer_store_dword v17, v16, s[28:31], 0 offen
  s_endpgm
L_H2:
  s_cmp_ge_u32 s2, 224
  s_cbranch_scc1 L_nogu
  s_cmp_ge_u32 s2, 192
  s_cbranch_scc1 L_gj0a
  s_lshr_b32 s59, s2, 6
  s_add_u32 s59, s59, 0
  s_cmp_eq_u32 s59, 3
  s_cselect_b32 s59, 0, s59
  s_add_u32 s58, s2, s59
  s_and_b32 s58, s58, 7
  s_lshl3_add_u32 s58, s59, s58
  s_mov_b32 s52, 0
  s_bfe_u32 s53, s2, 0x30003
  s_branch L_gj0b
L_gj0a:
  s_bfe_u32 s58, s2, 0x20001
  s_add_u32 s58, s58, 24
  s_and_b32 s52, s2, 1
  s_bfe_u32 s53, s2, 0x20003
  s_lshl1_add_u32 s53, s53, 0
L_gj0b:
  s_lshl1_add_u32 s58, s58, s52
  s_lshl3_add_u32 s58, s58, s53
  s_lshl_b32 s56, s58, 9
  s_cmp_ge_u32 s2, 192
  s_cbranch_scc1 L_gj1a
  s_lshr_b32 s59, s2, 6
  s_add_u32 s59, s59, 1
  s_cmp_eq_u32 s59, 3
  s_cselect_b32 s59, 0, s59
  s_add_u32 s58, s2, s59
  s_and_b32 s58, s58, 7
  s_lshl3_add_u32 s58, s59, s58
  s_mov_b32 s52, 1
  s_bfe_u32 s53, s2, 0x30003
  s_branch L_gj1b
L_gj1a:
  s_bfe_u32 s58, s2, 0x20001
  s_add_u32 s58, s58, 24
  s_and_b32 s52, s2, 1
  s_bfe_u32 s53, s2, 0x20003
  s_lshl1_add_u32 s53, s53, 1
L_gj1b:
  s_lshl1_add_u32 s58, s58, s52
  s_lshl3_add_u32 s58, s58, s53
  s_lshl_b32 s57, s58, 9
  s_sub_u32 s57, s57, 512
  v_mov_b32 v12, 152968
L_fm2:
  ds_read_b32 v11, v12
  s_waitcnt lgkmcnt(0)
  v_cmp_eq_u32 vcc, -1, v11
  s_nop 0
  s_cbranch_vccz L_fm2_ok
  s_sleep 4
  s_sub_u32 s62, s62, 1
  s_cmp_gt_i32 s62, 0
  s_cbranch_scc1 L_fm2
L_fm2_ok:
  v_readfirstlane_b32 s92, v11
  s_and_b32 s58, s2, 0xc1
  s_cmp_eq_u32 s58, 0xc1
  s_cselect_b32 s92, 0, s92
  v_mov_b32 v8, s57
  v_mov_b32 v10, s56
  v_cmp_gt_u32 vcc, 32, v1
  s_nop 1
  v_cndmask_b32 v8, v8, v10, vcc
  v_add_u32 v8, v8, v13
  v_and_b32 v10, 32, v1
  v_lshl_add_u32 v10, v10, 4, v13
  v_add_u32 v10, 155136, v10
L_gr:
  ds_read_b128 v[128:131], v10 offset:0
  ds_read_b128 v[132:135], v10 offset:512
  s_waitcnt lgkmcnt(0)
  v_max3_u32 v20, v128, v129, v130
  v_max3_u32 v20, v20, v131, v132
  v_max3_u32 v20, v20, v133, v134
  v_max_u32 v20, v20, v135
  v_cmp_eq_u32 vcc, -1, v20
  s_nop 0
  s_cbranch_vccz L_gr_ok
  s_sleep 4
  s_sub_u32 s62, s62, 1
  s_cmp_gt_i32 s62, 0
  s_cbranch_scc1 L_gr
L_gr_ok:
  v_add_f32 v128, v128, v132
  v_add_f32 v129, v129, v133
  v_add_f32 v130, v130, v134
  v_add_f32 v131, v131, v135
  v_add_u32 v128, 128, v128
  v_add_u32 v129, 128, v129
  v_add_u32 v130, 128, v130
  v_add_u32 v131, 128, v131
  v_and_or_b32 v128, v128, v15, s97
  v_and_or_b32 v129, v129, v15, s98
  v_and_or_b32 v130, v130, v15, s99
  v_and_or_b32 v131, v131, v15, s100
  s_cmp_eq_u32 s92, 1
  s_cbranch_scc0 L_stgf
  buffer_store_dwordx4 v[128:131], v8, s[28:31], 0 offen
  s_branch L_stgd
L_stgf:
  buffer_store_dwordx4 v[128:131], v8, s[28:31], 0 offen sc1
L_stgd:
  s_branch L_hget
L_nogu:
  s_and_b32 s53, s2, 0xf9
  s_cmp_eq_u32 s53, 0xf9
  s_cbranch_scc1 L_hget
  s_bfe_u32 s57, s2, 0x20003
  s_add_u32 s53, s2, s57
  s_and_b32 s53, s53, 7
  s_lshl3_add_u32 s53, s57, s53
  s_lshr_b32 s56, s2, 5
  s_bfe_u32 s56, s2, 0x20001
  s_add_u32 s56, s56, 24
  s_cmp_ge_u32 s2, 248
  s_cselect_b32 s53, s56, s53
  s_lshl_b32 s56, s53, 13
  s_add_u32 s57, s56, 4096
  s_lshl_b32 s58, s53, 9
  s_add_u32 s58, s58, 229376
  s_and_b32 s88, s96, 0xffff
  s_lshr_b32 s89, s96, 16
  v_cmp_gt_u32 vcc, 32, v1
  s_nop 1
  v_cndmask_b32 v8, v9, v13, vcc
  v_mov_b32 v12, 150016
L_qseen:
  ds_read_b32 v11, v12
  s_waitcnt lgkmcnt(0)
  v_cmp_eq_u32 vcc, -1, v11
  s_nop 0
  s_cbranch_vccz L_qseen_ok
  s_sleep 4
  s_sub_u32 s62, s62, 1
  s_cmp_gt_i32 s62, 0
  s_cbranch_scc1 L_qseen
L_qseen_ok:
  buffer_load_dwordx4 v[128:131], v13, s[28:31], s56 offen offset:0 sc1
  buffer_load_dwordx4 v[132:135], v13, s[28:31], s56 offen offset:1024 sc1
  buffer_load_dwordx4 v[136:139], v13, s[28:31], s56 offen offset:2048 sc1
  buffer_load_dwordx4 v[140:143], v13, s[28:31], s56 offen offset:3072 sc1
  buffer_load_dwordx4 v[144:147], v13, s[28:31], s57 offen offset:0 sc1
  buffer_load_dwordx4 v[148:151], v13, s[28:31], s57 offen offset:1024 sc1
  buffer_load_dwordx4 v[152:155], v13, s[28:31], s57 offen offset:2048 sc1
  buffer_load_dwordx4 v[156:159], v13, s[28:31], s57 offen offset:3072 sc1
L_gug:
  s_waitcnt vmcnt(0)
  v_xor_b32 v160, s97, v128
  v_xor_b32 v161, s98, v129
  v_xor_b32 v162, s99, v130
  v_xor_b32 v163, s100, v131
  v_or3_b32 v20, v160, v161, v162
  v_or_b32 v20, v20, v163
  v_xor_b32 v164, s97, v132
  v_xor_b32 v165, s98, v133
  v_xor_b32 v166, s99, v134
  v_xor_b32 v167, s100, v135
  v_or3_b32 v21, v164, v165, v166
  v_or_b32 v21, v21, v167
  v_xor_b32 v168, s97, v136
  v_xor_b32 v169, s98, v137
  v_xor_b32 v170, s99, v138
  v_xor_b32 v171, s100, v139
  v_or3_b32 v22, v168, v169, v170
  v_or_b32 v22, v22, v171
  v_xor_b32 v172, s97, v140
  v_xor_b32 v173, s98, v141
  v_xor_b32 v174, s99, v142
  v_xor_b32 v175, s100, v143
  v_or3_b32 v23, v172, v173, v174
  v_or_b32 v23, v23, v175
  v_xor_b32 v176, s97, v144
  v_xor_b32 v177, s98, v145
  v_xor_b32 v178, s99, v146
  v_xor_b32 v179, s100, v147
  v_or3_b32 v24, v176, v177, v178
  v_or_b32 v24, v24, v179
  v_xor_b32 v180, s97, v148
  v_xor_b32 v181, s98, v149
  v_xor_b32 v182, s99, v150
  v_xor_b32 v183, s100, v151
  v_or3_b32 v25, v180, v181, v182
  v_or_b32 v25, v25, v183
  v_xor_b32 v184, s97, v152
  v_xor_b32 v185, s98, v153
  v_xor_b32 v186, s99, v154
  v_xor_b32 v187, s100, v155
  v_or3_b32 v26, v184, v185, v186
  v_or_b32 v26, v26, v187
  v_xor_b32 v188, s97, v156
  v_xor_b32 v189, s98, v157
  v_xor_b32 v190, s99, v158
  v_xor_b32 v191, s100, v159
  v_or3_b32 v27, v188, v189, v190
  v_or_b32 v27, v27, v191
  v_or3_b32 v28, v20, v21, v22
  v_or3_b32 v28, v28, v23, v24
  v_or3_b32 v28, v28, v25, v26
  v_or_b32 v28, v28, v27
  v_and_b32 v28, 0xff, v28
  v_cmp_ne_u32 vcc, 0, v28
  s_nop 0
  s_cbranch_vccz L_gug_ok
  s_sleep 4
  v_and_b32 v28, 0xff, v20
  v_cmp_ne_u32 vcc, 0, v28
  s_nop 0
  s_cbranch_vccz L_gug_s0
  buffer_load_dwordx4 v[128:131], v13, s[28:31], s56 offen offset:0 sc1
L_gug_s0:
  v_and_b32 v28, 0xff, v21
  v_cmp_ne_u32 vcc, 0, v28
  s_nop 0
  s_cbranch_vccz L_gug_s1
  buffer_load_dwordx4 v[132:135], v13, s[28:31], s56 offen offset:1024 sc1
L_gug_s1:
  v_and_b32 v28, 0xff, v22
  v_cmp_ne_u32 vcc, 0, v28
  s_nop 0
  s_cbranch_vccz L_gug_s2
  buffer_load_dwordx4 v[136:139], v13, s[28:31], s56 offen offset:2048 sc1
L_gug_s2:
  v_and_b32 v28, 0xff, v23
  v_cmp_ne_u32 vcc, 0, v28
  s_nop 0
  s_cbranch_vccz L_gug_s3
  buffer_load_dwordx4 v[140:143], v13, s[28:31], s56 offen offset:3072 sc1
L_gug_s3:
  v_and_b32 v28, 0xff, v24
  v_cmp_ne_u32 vcc, 0, v28
  s_nop 0
  s_cbranch_vccz L_gug_s4
  buffer_load_dwordx4 v[144:147], v13, s[28:31], s57 offen offset:0 sc1
L_gug_s4:
  v_and_b32 v28, 0xff, v25
  v_cmp_ne_u32 vcc, 0, v28
  s_nop 0
  s_cbranch_vccz L_gug_s5
  buffer_load_dwordx4 v[148:151], v13, s[28:31], s57 offen offset:1024 sc1
L_gug_s5:
  v_and_b32 v28, 0xff, v26
  v_cmp_ne_u32 vcc, 0, v28
  s_nop 0
  s_cbranch_vccz L_gug_s6
  buffer_load_dwordx4 v[152:155], v13, s[28:31], s57 offen offset:2048 sc1
L_gug_s6:
  v_and_b32 v28, 0xff, v27
  v_cmp_ne_u32 vcc, 0, v28
  s_nop 0
  s_cbranch_vccz L_gug_s7
  buffer_load_dwordx4 v[156:159], v13, s[28:31], s57 offen offset:3072 sc1
L_gug_s7:
  s_waitcnt vmcnt(0)
  s_sub_u32 s62, s62, 1
  s_cmp_gt_i32 s62, 0
  s_cbranch_scc1 L_gug
L_gug_ok:
  v_add_f32 v160, v160, v164
  v_add_f32 v168, v168, v172
  v_add_f32 v161, v161, v165
  v_add_f32 v169, v169, v173
  v_add_f32 v162, v162, v166
  v_add_f32 v170, v170, v174
  v_add_f32 v163, v163, v167
  v_add_f32 v171, v171, v175
  v_add_f32 v160, v160, v168
  v_add_f32 v161, v161, v169
  v_add_f32 v162, v162, v170
  v_add_f32 v163, v163, v171
  v_mov_b32 v164, v160
  v_mov_b32 v165, v161
  v_mov_b32 v166, v162
  v_mov_b32 v167, v163
  v_permlane32_swap_b32 v164, v160
  v_permlane32_swap_b32 v165, v161
  v_permlane32_swap_b32 v166, v162
  v_permlane32_swap_b32 v167, v163
  v_add_f32 v160, v160, v164
  v_add_f32 v161, v161, v165
  v_add_f32 v162, v162, v166
  v_add_f32 v163, v163, v167
  v_add_f32 v176, v176, v180
  v_add_f32 v184, v184, v188
  v_add_f32 v177, v177, v181
  v_add_f32 v185, v185, v189
  v_add_f32 v178, v178, v182
  v_add_f32 v186, v186, v190
  v_add_f32 v179, v179, v183
  v_add_f32 v187, v187, v191
  v_add_f32 v176, v176, v184
  v_add_f32 v177, v177, v185
  v_add_f32 v178, v178, v186
  v_add_f32 v179, v179, v187
  v_mov_b32 v180, v176
  v_mov_b32 v181, v177
  v_mov_b32 v182, v178
  v_mov_b32 v183, v179
  v_permlane32_swap_b32 v180, v176
  v_permlane32_swap_b32 v181, v177
  v_permlane32_swap_b32 v182, v178
  v_permlane32_swap_b32 v183, v179
  v_add_f32 v176, v176, v180
  v_add_f32 v177, v177, v181
  v_add_f32 v178, v178, v182
  v_add_f32 v179, v179, v183
  v_cvt_pk_bf16_f32 v160, v160, v160
  v_lshlrev_b32 v160, 16, v160
  v_cvt_pk_bf16_f32 v176, v176, v176
  v_lshlrev_b32 v176, 16, v176
  v_mul_f32 v24, 0xbfb8aa3b, v160
  v_exp_f32 v24, v24
  s_nop 0
  v_add_f32 v24, 1.0, v24
  v_rcp_f32 v24, v24
  s_nop 0
  v_mul_f32 v160, v160, v24
  v_cvt_pk_bf16_f32 v160, v160, v160
  v_lshlrev_b32 v160, 16, v160
  v_mul_f32 v20, v160, v176
  v_cvt_pk_bf16_f32 v20, v20, v20
  v_lshlrev_b32 v20, 16, v20
  v_or_b32 v20, s88, v20
  v_cvt_pk_bf16_f32 v161, v161, v161
  v_lshlrev_b32 v161, 16, v161
  v_cvt_pk_bf16_f32 v177, v177, v177
  v_lshlrev_b32 v177, 16, v177
  v_mul_f32 v24, 0xbfb8aa3b, v161
  v_exp_f32 v24, v24
  s_nop 0
  v_add_f32 v24, 1.0, v24
  v_rcp_f32 v24, v24
  s_nop 0
  v_mul_f32 v161, v161, v24
  v_cvt_pk_bf16_f32 v161, v161, v161
  v_lshlrev_b32 v161, 16, v161
  v_mul_f32 v21, v161, v177
  v_cvt_pk_bf16_f32 v21, v21, v21
  v_lshlrev_b32 v21, 16, v21
  v_or_b32 v21, s89, v21
  v_cvt_pk_bf16_f32 v162, v162, v162
  v_lshlrev_b32 v162, 16, v162
  v_cvt_pk_bf16_f32 v178, v178, v178
  v_lshlrev_b32 v178, 16, v178
  v_mul_f32 v24, 0xbfb8aa3b, v162
  v_exp_f32 v24, v24
  s_nop 0
  v_add_f32 v24, 1.0, v24
  v_rcp_f32 v24, v24
  s_nop 0
  v_mul_f32 v162, v162, v24
  v_cvt_pk_bf16_f32 v162, v162, v162
  v_lshlrev_b32 v162, 16, v162
  v_mul_f32 v22, v162, v178
  v_cvt_pk_bf16_f32 v22, v22, v22
  v_lshlrev_b32 v22, 16, v22
  v_or_b32 v22, s88, v22
  v_cvt_pk_bf16_f32 v163, v163, v163
  v_lshlrev_b32 v163, 16, v163
  v_cvt_pk_bf16_f32 v179, v179, v179
  v_lshlrev_b32 v179, 16, v179
  v_mul_f32 v24, 0xbfb8aa3b, v163
  v_exp_f32 v24, v24
  s_nop 0
  v_add_f32 v24, 1.0, v24
  v_rcp_f32 v24, v24
  s_nop 0
  v_mul_f32 v163, v163, v24
  v_cvt_pk_bf16_f32 v163, v163, v163
  v_lshlrev_b32 v163, 16, v163
  v_mul_f32 v23, v163, v179
  v_cvt_pk_bf16_f32 v23, v23, v23
  v_lshlrev_b32 v23, 16, v23
  v_or_b32 v23, s89, v23
  buffer_store_dwordx4 v[20:23], v8, s[28:31], s58 offen sc1
L_hget:
  s_branch L_H23
L_H3:
  s_getreg_b32 s52, hwreg(HW_REG_XCC_ID, 0, 4)
  s_xor_b32 s53, s96, 0x5a5a5a50
  s_and_b32 s53, s53, -16
  s_lshl_b32 s56, s55, 8
  s_add_u32 s56, s56, 249856
  v_and_b32 v10, 31, v1
  v_lshlrev_b32 v10, 3, v10
  s_or_b32 s53, s53, s52
  s_mov_b32 s57, 10
  v_mov_b32 v12, 153016
L_f4:
  ds_read_b32 v11, v12
  s_waitcnt lgkmcnt(0)
  v_cmp_eq_u32 vcc, -1, v11
  s_nop 0
  s_cbranch_vccz L_f4_ok
  s_sleep 2
  s_sub_u32 s62, s62, 1
  s_cmp_gt_i32 s62, 0
  s_cbranch_scc1 L_f4
L_f4_ok:
L_xc:
  buffer_load_dwordx2 v[32:33], v10, s[28:31], s56 offen sc1
  s_mov_b32 s52, 1
  s_waitcnt vmcnt(0)
  v_xor_b32 v20, s96, v32
  v_xor_b32 v21, s53, v33
  v_or_b32 v20, v20, v21
  v_cmp_ne_u32 vcc, 0, v20
  s_nop 0
  s_cbranch_vccz L_xc_ok
  s_mov_b32 s52, 0
  s_sub_u32 s57, s57, 1
  s_cmp_lg_u32 s57, 0
  s_cbranch_scc1 L_xc
L_xc_ok:
  v_mov_b32 v10, 152960
  v_mov_b32 v11, s52
  ds_write_b32 v10, v11 offset:8
  v_lshlrev_b32 v10, 3, v14
  v_add_u32 v11, 152192, v10
  s_mov_b32 s88, 1069066811
  s_lshr_b32 s90, s96, 16
  s_and_b32 s97, s96, 0xfff
  s_bfe_u32 s52, s2, 0x20003
  s_lshr_b32 s53, s2, 5
  s_lshl_b32 s53, s53, 3
  s_and_b32 s89, s2, 7
  s_add_u32 s53, s53, s89
  s_lshl_b32 s89, s52, 6
  s_add_u32 s89, s89, s53
  s_lshl_b32 s89, s89, 6
  s_add_u32 s89, s89, 1310720
  v_cmp_gt_u32 vcc, 8, v1
  s_nop 1
  v_cndmask_b32 v10, v9, v10, vcc
  v_mov_b32 v15, 0xfffff000
L_mlp_w:
  ds_read_b64 v[20:21], v11 offset:0
  ds_read_b64 v[22:23], v11 offset:64
  ds_read_b64 v[24:25], v11 offset:128
  ds_read_b64 v[26:27], v11 offset:192
  s_waitcnt lgkmcnt(0)
  v_max3_u32 v28, v20, v21, v22
  v_max3_u32 v28, v28, v23, v24
  v_max3_u32 v28, v28, v25, v26
  v_max_u32 v28, v28, v27
  v_cmp_eq_u32 vcc, -1, v28
  s_nop 0
  s_cbranch_vccz L_mlp_w_ok
  s_sleep 4
  s_sub_u32 s62, s62, 1
  s_cmp_gt_i32 s62, 0
  s_cbranch_scc1 L_mlp_w
L_mlp_w_ok:
  v_max3_f32 v28, v20, v22, v24
  v_max_f32 v28, v28, v26
  v_mul_f32 v30, s88, v28
  v_ceil_f32 v30, v30
  v_fma_f32 v20, v20, s88, -v30
  v_exp_f32 v20, v20
  v_fma_f32 v22, v22, s88, -v30
  v_exp_f32 v22, v22
  v_fma_f32 v24, v24, s88, -v30
  v_exp_f32 v24, v24
  v_fma_f32 v26, v26, s88, -v30
  v_exp_f32 v26, v26
  v_mul_f32 v33, v20, v21
  v_fmac_f32 v33, v22, v23
  v_fmac_f32 v33, v24, v25
  v_fmac_f32 v33, v26, v27
  v_add_u32 v33, 2048, v33
  v_and_or_b32 v33, v33, v15, s97
  v_or_b32 v32, s90, v28
  buffer_store_dwordx2 v[32:33], v10, s[28:31], s89 offen sc1
L_H23:
  s_cmp_ge_u32 s2, 224
  s_cbranch_scc1 L_ofin
  s_endpgm
L_ofin:
  v_mov_b32 v20, s96
  v_and_b32 v19, 7, v1
  v_lshlrev_b32 v21, 2, v19
  v_alignbit_b32 v20, v20, v20, v21
  v_alignbit_b32 v28, v20, v20, 0
  v_and_b32 v28, 0x10001, v28
  v_alignbit_b32 v29, v20, v20, 1
  v_and_b32 v29, 0x10001, v29
  v_alignbit_b32 v30, v20, v20, 2
  v_and_b32 v30, 0x10001, v30
  v_alignbit_b32 v31, v20, v20, 3
  v_and_b32 v31, 0x10001, v31
  s_and_b32 s88, s2, 7
  s_bfe_u32 s89, s2, 0x20003
  s_lshl_b32 s57, s89, 12
  s_lshl_b32 s53, s3, 4
  s_add_u32 s57, s57, s53
  s_add_u32 s57, s57, 1310720
  v_add_u32 v7, s88, v19
  v_and_b32 v7, 7, v7
  v_and_b32 v8, 56, v1
  v_add_lshl_u32 v7, v7, v8, 6
  s_lshr_b32 s90, s96, 16
  s_and_b32 s91, s96, 0xfff
  s_mov_b32 s58, 1069066811
  v_and_b32 v10, 1, v1
  v_lshlrev_b32 v10, 4, v10
  v_mov_b32 v11, 0xffff
  v_lshlrev_b32 v10, v10, v11
  v_bfe_u32 v11, v1, 1, 2
  v_cmp_eq_u32 vcc, 0, v11
  s_nop 1
  v_cndmask_b32 v24, 0, v10, vcc
  v_cmp_eq_u32 vcc, 1, v11
  s_nop 1
  v_cndmask_b32 v25, 0, v10, vcc
  v_cmp_eq_u32 vcc, 2, v11
  s_nop 1
  v_cndmask_b32 v26, 0, v10, vcc
  v_cmp_eq_u32 vcc, 3, v11
  s_nop 1
  v_cndmask_b32 v27, 0, v10, vcc
  s_lshl2_add_u32 s48, s88, s89
  s_lshl2_add_u32 s48, s48, s3
  s_lshl_b32 s48, s48, 12
  s_add_u32 s48, s48, 786432
  s_lshl2_add_u32 s56, s89, s3
  s_lshl_b32 s56, s56, 13
  s_lshl_b32 s53, s88, 9
  s_add_u32 s56, s56, s53
  s_add_u32 s56, s56, 1474560
  v_and_b32 v10, 8, v1
  v_lshlrev_b32 v10, 9, v10
  v_and_b32 v11, 32, v1
  v_lshl_add_u32 v10, v11, 3, v10
  v_lshl_add_u32 v10, v19, 5, v10
  v_and_b32 v11, 16, v1
  v_add_u32 v10, v10, v11
  v_lshlrev_b32 v8, 4, v1
  v_mov_b32 v14, 152976
  v_mov_b32 v18, 4294901758
  s_sub_u32 s56, s56, 1474560
  s_lshr_b32 s56, s56, 1
  s_add_u32 s56, s56, 1474560
  v_lshrrev_b32 v10, 1, v10
  v_mov_b32 v4, v28
  v_mov_b32 v5, v29
  s_nop 0
  v_mov_b32_dpp v4, v30 quad_perm:[0,1,2,3] row_mask:0xa bank_mask:0xf
  v_mov_b32_dpp v5, v31 quad_perm:[0,1,2,3] row_mask:0xa bank_mask:0xf
  s_bfe_u32 s97, s96, 786432
  s_bfe_u32 s98, s96, 786444
  s_bfe_u32 s99, s96, 786452
  s_bfe_u32 s100, s96, 786438
L_f3m:
  ds_read_b128 v[56:59], v14
  s_waitcnt lgkmcnt(0)
  v_max3_u32 v22, v56, v57, v58
  v_max_u32 v22, v22, v59
  v_cmp_eq_u32 vcc, -1, v22
  s_nop 0
  s_cbranch_vccz L_f3m_ok
  s_sleep 4
  s_sub_u32 s62, s62, 1
  s_cmp_gt_i32 s62, 0
  s_cbranch_scc1 L_f3m
L_f3m_ok:
  buffer_load_dwordx4 v[32:35], v7, s[28:31], s57 offen sc1
L_mlg:
  s_waitcnt vmcnt(0)
  v_xor_b32 v36, s90, v32
  v_xor_b32 v37, s91, v33
  v_xor_b32 v38, s90, v34
  v_xor_b32 v39, s91, v35
  v_or_b32 v22, v37, v39
  v_and_b32 v22, 0xfff, v22
  v_or3_b32 v22, v22, v36, v38
  v_and_b32 v23, 0xffff, v22
  v_cmp_ne_u32 vcc, 0, v23
  s_nop 0
  s_cbranch_vccz L_mlg_ok
  s_sleep 4
  s_mov_b64 exec, vcc
  buffer_load_dwordx4 v[32:35], v7, s[28:31], s57 offen sc1
  s_mov_b64 exec, -1
  s_waitcnt vmcnt(0)
  s_sub_u32 s62, s62, 1
  s_cmp_gt_i32 s62, 0
  s_cbranch_scc1 L_mlg
L_mlg_ok:
  v_mul_f32 v36, s58, v36
  v_ceil_f32 v36, v36
  v_mov_b32 v22, v36
  s_nop 1
  v_max_f32_dpp v22, v22, v22 row_ror:8 row_mask:0xf bank_mask:0xf
  s_nop 1
  v_max_f32_dpp v22, v22, v22 row_ror:4 row_mask:0xf bank_mask:0xf
  s_nop 1
  v_max_f32_dpp v22, v22, v22 row_ror:2 row_mask:0xf bank_mask:0xf
  s_nop 1
  v_max_f32_dpp v22, v22, v22 row_ror:1 row_mask:0xf bank_mask:0xf
  v_mov_b32 v23, v22
  s_nop 1
  v_permlane16_swap_b32 v23, v22
  v_max_f32 v22, v22, v23
  v_mov_b32 v23, v22
  s_nop 1
  v_permlane32_swap_b32 v23, v22
  v_max_f32 v22, v22, v23
  v_sub_f32 v36, v36, v22
  v_cvt_i32_f32 v36, v36
  v_ldexp_f32 v36, 1.0, v36
  v_mul_f32 v37, v36, v37
  s_nop 1
  v_add_f32_dpp v37, v37, v37 row_ror:8 row_mask:0xf bank_mask:0xf
  s_nop 1
  v_add_f32_dpp v37, v37, v37 row_ror:4 row_mask:0xf bank_mask:0xf
  s_nop 1
  v_add_f32_dpp v37, v37, v37 row_ror:2 row_mask:0xf bank_mask:0xf
  s_nop 1
  v_add_f32_dpp v37, v37, v37 row_ror:1 row_mask:0xf bank_mask:0xf
  v_mov_b32 v23, v37
  s_nop 1
  v_permlane16_swap_b32 v23, v37
  v_add_f32 v37, v37, v23
  v_mov_b32 v23, v37
  s_nop 1
  v_permlane32_swap_b32 v23, v37
  v_add_f32 v37, v37, v23
  v_perm_b32 v36, v36, v36, s61
  s_nop 1
  v_mov_b32_dpp v22, v36 row_newbcast:0 row_mask:0xf bank_mask:0x3
  s_nop 1
  v_mov_b32_dpp v22, v36 row_newbcast:8 row_mask:0xf bank_mask:0xc
  v_and_b32 v40, v22, v24
  v_and_b32 v41, v22, v25
  v_and_b32 v42, v22, v26
  v_and_b32 v43, v22, v27
  v_mul_f32 v38, s58, v38
  v_ceil_f32 v38, v38
  v_mov_b32 v22, v38
  s_nop 1
  v_max_f32_dpp v22, v22, v22 row_ror:8 row_mask:0xf bank_mask:0xf
  s_nop 1
  v_max_f32_dpp v22, v22, v22 row_ror:4 row_mask:0xf bank_mask:0xf
  s_nop 1
  v_max_f32_dpp v22, v22, v22 row_ror:2 row_mask:0xf bank_mask:0xf
  s_nop 1
  v_max_f32_dpp v22, v22, v22 row_ror:1 row_mask:0xf bank_mask:0xf
  v_mov_b32 v23, v22
  s_nop 1
  v_permlane16_swap_b32 v23, v22
  v_max_f32 v22, v22, v23
  v_mov_b32 v23, v22
  s_nop 1
  v_permlane32_swap_b32 v23, v22
  v_max_f32 v22, v22, v23
  v_sub_f32 v38, v38, v22
  v_cvt_i32_f32 v38, v38
  v_ldexp_f32 v38, 1.0, v38
  v_mul_f32 v39, v38, v39
  s_nop 1
  v_add_f32_dpp v39, v39, v39 row_ror:8 row_mask:0xf bank_mask:0xf
  s_nop 1
  v_add_f32_dpp v39, v39, v39 row_ror:4 row_mask:0xf bank_mask:0xf
  s_nop 1
  v_add_f32_dpp v39, v39, v39 row_ror:2 row_mask:0xf bank_mask:0xf
  s_nop 1
  v_add_f32_dpp v39, v39, v39 row_ror:1 row_mask:0xf bank_mask:0xf
  v_mov_b32 v23, v39
  s_nop 1
  v_permlane16_swap_b32 v23, v39
  v_add_f32 v39, v39, v23
  v_mov_b32 v23, v39
  s_nop 1
  v_permlane32_swap_b32 v23, v39
  v_add_f32 v39, v39, v23
  v_perm_b32 v38, v38, v38, s61
  s_nop 1
  v_mov_b32_dpp v22, v38 row_newbcast:0 row_mask:0xf bank_mask:0x3
  s_nop 1
  v_mov_b32_dpp v22, v38 row_newbcast:8 row_mask:0xf bank_mask:0xc
  v_and_b32 v44, v22, v24
  v_and_b32 v45, v22, v25
  v_and_b32 v46, v22, v26
  v_and_b32 v47, v22, v27
  v_mov_b32_dpp v37, v39 quad_perm:[0,1,2,3] row_mask:0xf bank_mask:0xc
  v_rcp_f32 v17, v37
L_f3o:
  ds_read_b128 v[56:59], v14
  s_waitcnt lgkmcnt(0)
  v_max3_u32 v22, v56, v57, v58
  v_max_u32 v22, v22, v59
  v_cmp_eq_u32 vcc, -1, v22
  s_nop 0
  s_cbranch_vccz L_f3o_ok
  s_sleep 2
  s_sub_u32 s62, s62, 1
  s_cmp_gt_i32 s62, 0
  s_cbranch_scc1 L_f3o
L_f3o_ok:
  buffer_load_dwordx4 v[64:67], v8, s[28:31], s48 offen offset:0 sc1
  buffer_load_dwordx4 v[68:71], v8, s[28:31], s48 offen offset:1024 sc1
  buffer_load_dwordx4 v[72:75], v8, s[28:31], s48 offen offset:2048 sc1
  buffer_load_dwordx4 v[76:79], v8, s[28:31], s48 offen offset:3072 sc1
L_ol:
  s_waitcnt vmcnt(3)
  v_xor_b32 v80, v28, v64
  v_xor_b32 v81, v29, v65
  v_xor_b32 v82, v30, v66
  v_xor_b32 v83, v31, v67
  v_or3_b32 v48, v80, v81, v82
  v_or_b32 v48, v48, v83
  v_mfma_f32_16x16x32_bf16 v[96:99], v[40:43], v[80:83], 0
  s_waitcnt vmcnt(2)
  v_xor_b32 v84, v28, v68
  v_xor_b32 v85, v29, v69
  v_xor_b32 v86, v30, v70
  v_xor_b32 v87, v31, v71
  v_or3_b32 v49, v84, v85, v86
  v_or_b32 v49, v49, v87
  v_mfma_f32_16x16x32_bf16 v[100:103], v[40:43], v[84:87], 0
  s_waitcnt vmcnt(1)
  v_xor_b32 v88, v28, v72
  v_xor_b32 v89, v29, v73
  v_xor_b32 v90, v30, v74
  v_xor_b32 v91, v31, v75
  v_or3_b32 v50, v88, v89, v90
  v_or_b32 v50, v50, v91
  v_mfma_f32_16x16x32_bf16 v[104:107], v[44:47], v[88:91], 0
  s_waitcnt vmcnt(0)
  v_xor_b32 v92, v28, v76
  v_xor_b32 v93, v29, v77
  v_xor_b32 v94, v30, v78
  v_xor_b32 v95, v31, v79
  v_or3_b32 v51, v92, v93, v94
  v_or_b32 v51, v51, v95
  v_mfma_f32_16x16x32_bf16 v[108:111], v[44:47], v[92:95], 0
  v_or3_b32 v52, v48, v49, v50
  v_or_b32 v52, v52, v51
  v_and_b32 v52, 0x10001, v52
  v_cmp_ne_u32 vcc, 0, v52
  s_nop 0
  s_cbranch_vccz L_ol_ok
  buffer_load_dwordx4 v[64:67], v8, s[28:31], s48 offen offset:0 sc1
  buffer_load_dwordx4 v[68:71], v8, s[28:31], s48 offen offset:1024 sc1
  buffer_load_dwordx4 v[72:75], v8, s[28:31], s48 offen offset:2048 sc1
  buffer_load_dwordx4 v[76:79], v8, s[28:31], s48 offen offset:3072 sc1
  s_sub_u32 s62, s62, 1
  s_cmp_gt_i32 s62, 0
  s_cbranch_scc1 L_ol
  s_waitcnt vmcnt(0)
L_ol_ok:
  v_permlane32_swap_b32 v96, v100
  v_permlane32_swap_b32 v97, v101
  v_permlane32_swap_b32 v98, v102
  v_permlane32_swap_b32 v99, v103
  v_permlane32_swap_b32 v104, v108
  v_permlane32_swap_b32 v105, v109
  v_permlane32_swap_b32 v106, v110
  v_permlane32_swap_b32 v107, v111
  v_add_f32_dpp v20, v100, v96 row_ror:8 row_mask:0xf bank_mask:0x3
  v_add_f32_dpp v21, v101, v97 row_ror:8 row_mask:0xf bank_mask:0x3
  v_add_f32_dpp v22, v102, v98 row_ror:8 row_mask:0xf bank_mask:0x3
  v_add_f32_dpp v23, v103, v99 row_ror:8 row_mask:0xf bank_mask:0x3
  v_add_f32_dpp v20, v104, v108 row_ror:8 row_mask:0xf bank_mask:0xc
  v_add_f32_dpp v21, v105, v109 row_ror:8 row_mask:0xf bank_mask:0xc
  v_add_f32_dpp v22, v106, v110 row_ror:8 row_mask:0xf bank_mask:0xc
  v_add_f32_dpp v23, v107, v111 row_ror:8 row_mask:0xf bank_mask:0xc
  v_mul_f32 v20, v17, v20
  v_mul_f32 v21, v17, v21
  v_mul_f32 v22, v17, v22
  v_mul_f32 v23, v17, v23
  v_add_u32 v20, 0x10000, v20
  v_add_u32 v21, 0x10000, v21
  v_add_u32 v22, 0x10000, v22
  v_add_u32 v23, 0x10000, v23
  v_perm_b32 v20, v21, v20, s61
  v_perm_b32 v21, v23, v22, s61
  v_and_or_b32 v20, v20, v18, v4
  v_and_or_b32 v21, v21, v18, v5
  buffer_store_dwordx2 v[20:21], v10, s[28:31], s56 offen sc1
  s_lshl_b32 s53, s3, 2
  v_add_u32 v14, s53, v14
  ds_write_b32 v14, v14 offset:16
  s_cmp_eq_u32 s3, 0
  s_cbranch_scc1 L_H0b
  s_cmp_eq_u32 s3, 1
  s_cbranch_scc1 L_H1b
  s_waitcnt lgkmcnt(0)
  s_endpgm
L_exit:
  s_endpgm
.section .rodata,"a"
.p2align 6
.amdhsa_kernel recurrent_scan__gqa_block_cached__swiglu_ffn__decode_kernel
  .amdhsa_next_free_vgpr 256
  .amdhsa_next_free_sgpr 102
  .amdhsa_accum_offset 256
  .amdhsa_group_segment_fixed_size 0
  .amdhsa_kernarg_size 96
  .amdhsa_user_sgpr_count 2
  .amdhsa_user_sgpr_kernarg_segment_ptr 1
  .amdhsa_system_sgpr_workgroup_id_x 1
  .amdhsa_float_denorm_mode_32 3
.end_amdhsa_kernel
```
